```python
import torch

def _softmax(x, axis=-1):
    return torch.softmax(x, dim=axis)
def _gelu(x):
    return torch.nn.functional.gelu(x, approximate="tanh")
def _silu(x):
    return torch.nn.functional.silu(x)
def _sigmoid(x):
    return torch.sigmoid(x)
def _layernorm(x, axis=-1, eps=1e-5):
    m = x.mean(dim=axis, keepdim=True)
    v = x.var(dim=axis, keepdim=True, unbiased=False)
    return (x - m) / torch.sqrt(v + eps)
def _scatter_add(tgt, idx, src, axis=0):
    return tgt.clone().index_add_(axis, idx, src)
def _segment_sum(src, seg, n):
    out = torch.zeros((n,) + src.shape[1:], dtype=src.dtype)
    return out.index_add_(0, seg, src)
def _pad(x, pw):
    flat = tuple(v for pair in reversed(pw) for v in pair)
    return torch.nn.functional.pad(x, flat)

kernel_name = 'recurrent_scan__ssm_conv_s5__glu_gated_swiglu__prompt'

def setup_inputs():

    _w = (lambda a: (lambda t: t.to(torch.bfloat16) if t.is_floating_point() else t)(torch.as_tensor(a)))
    def _A_setup():
        B, S, D = 1, 2048, 640
        P = D
        Lambda_re = -0.5 * (lambda _x: torch.exp(torch.as_tensor(_x)))((lambda *s: torch.randn(*s, dtype=torch.bfloat16) * 0.8)(P))
        Lambda_im = (lambda *s: torch.randn(*s, dtype=torch.bfloat16) * 0.8)(P) * 1.0
        B_re = (lambda *s: torch.randn(*s, dtype=torch.bfloat16) * 0.8)(P, D) * (D ** -0.5)
        B_im = (lambda *s: torch.randn(*s, dtype=torch.bfloat16) * 0.8)(P, D) * (D ** -0.5)
        C_re = (lambda *s: torch.randn(*s, dtype=torch.bfloat16) * 0.8)(D, P) * (P ** -0.5)
        C_im = (lambda *s: torch.randn(*s, dtype=torch.bfloat16) * 0.8)(D, P) * (P ** -0.5)
        log_dt = (lambda *s: torch.randn(*s, dtype=torch.bfloat16) * 0.8)(P) * 0.3 - 2.0
        Dskip = (lambda *s: torch.randn(*s, dtype=torch.bfloat16) * 0.8)(D)
        return {
            "x": _w((lambda *s: torch.randn(*s, dtype=torch.bfloat16) * 0.05)(B, S, D)),
            "Lambda_re": _w(Lambda_re),
            "Lambda_im": _w(Lambda_im),
            "B_re": _w(B_re),
            "B_im": _w(B_im),
            "C_re": _w(C_re),
            "C_im": _w(C_im),
            "log_dt": _w(log_dt),
            "Dskip": _w(Dskip),
        }
    _A_in = _A_setup()

    def _B_setup():
        B, S, D, F = 1, 2048, 640, 1536
        return {
            "x": _w((lambda *s: torch.randn(*s, dtype=torch.bfloat16) * 0.05)(B, S, D)),
            "w1": _w((lambda *s: torch.randn(*s, dtype=torch.bfloat16) * 0.2)(D, F) * (2.0 / D) ** 0.5),
            "w3": _w((lambda *s: torch.randn(*s, dtype=torch.bfloat16) * 0.2)(D, F) * (2.0 / D) ** 0.5),
            "w2": _w((lambda *s: torch.randn(*s, dtype=torch.bfloat16) * 0.2)(F, D) * (2.0 / F) ** 0.5),
        }
    _B_in = _B_setup()

    return {
        "A_x": _A_in["x"],
        "A_Lambda_re": _A_in["Lambda_re"],
        "A_Lambda_im": _A_in["Lambda_im"],
        "A_B_re": _A_in["B_re"],
        "A_B_im": _A_in["B_im"],
        "A_C_re": _A_in["C_re"],
        "A_C_im": _A_in["C_im"],
        "A_log_dt": _A_in["log_dt"],
        "A_Dskip": _A_in["Dskip"],
        "B_x": _B_in["x"],
        "B_w1": _B_in["w1"],
        "B_w3": _B_in["w3"],
        "B_w2": _B_in["w2"],
    }

def reference(A_x, A_Lambda_re, A_Lambda_im, A_B_re, A_B_im, A_C_re, A_C_im, A_log_dt, A_Dskip, B_x, B_w1, B_w3, B_w2):
    def _A_ref(x, Lambda_re, Lambda_im, B_re, B_im, C_re, C_im, log_dt, Dskip):
        Bsz, L, H = x.shape
        Lam = Lambda_re + 1j * Lambda_im
        Bmat = B_re + 1j * B_im
        Cmat = C_re + 1j * C_im
        dt = torch.exp(log_dt)
        Lam_bar = torch.exp(dt * Lam)
        B_bar = ((Lam_bar - 1.0) / Lam)[:, None] * Bmat
        Bu = torch.einsum("bld,pd->blp", x + 0j, B_bar)
        h = torch.zeros_like(Bu[:, 0, :])
        hs = []
        for t in range(L):
            h = Lam_bar[None, :] * h + Bu[:, t, :]
            hs.append(h)
        hseq = torch.stack(hs, 1)
        y = 2.0 * torch.einsum("blp,dp->bld", hseq, Cmat).real + x * Dskip[None, None, :]
        return y

    def _B_ref(x, w1, w3, w2):
        gate = torch.einsum("bsd,df->bsf", x, w1)
        up = torch.einsum("bsd,df->bsf", x, w3)
        h = _silu(gate) * up
        out = torch.einsum("bsf,fd->bsd", h, w2)
        return out

    x = A_x
    xn = _layernorm(x, axis=-1)
    s = _A_ref(xn, A_Lambda_re, A_Lambda_im, A_B_re, A_B_im, A_C_re, A_C_im, A_log_dt, A_Dskip)
    g = _silu(_B_ref(xn, B_w1, B_w3, B_w2))
    return x + s * g
```

```asm
; @launch grid=(256,1,1) block=(256,1,1) lds=163840
.amdgcn_target "amdgcn-amd-amdhsa--gfx950"
.text
.globl recurrent_scan__ssm_conv_s5__glu_gated_swiglu__prompt_kernel
.p2align 8
.type recurrent_scan__ssm_conv_s5__glu_gated_swiglu__prompt_kernel,@function
recurrent_scan__ssm_conv_s5__glu_gated_swiglu__prompt_kernel:
    s_cmp_ge_u32 s2, 256
    s_cbranch_scc1 L_exit
    s_load_dwordx16 s[4:19], s[0:1], 0
    s_load_dwordx16 s[20:35], s[0:1], 64
    s_getpc_b64 s[72:73]
L_pc:
    s_lshr_b32 s97, s2, 3
    s_mul_i32 s97, s97, 1536
    v_min_u32 v32, 11, v0
    v_lshlrev_b32 v32, 7, v32
    v_add_u32 v32, s97, v32
    v_min_u32 v32, L_codeend-L_pc-4, v32
    v_mov_b32 v33, s73
    v_add_co_u32 v32, vcc, s72, v32
    v_cmp_gt_u32 s[88:89], 12, v0
    s_nop 0
    v_addc_co_u32 v33, vcc, 0, v33, vcc
    s_and_b64 s[88:89], s[88:89], exec
    s_cbranch_scc0 L_nopf
    s_mov_b64 exec, s[88:89]
    global_load_dword a230, v[32:33], off
    s_mov_b64 exec, -1
L_nopf:
    v_lshrrev_b32 v32, 6, v0
    v_and_b32 v1, 63, v0
    v_readfirstlane_b32 s64, v32
    v_lshlrev_b32 v2, 4, v1
    s_and_b32 s70, s2, 7
    s_lshr_b32 s71, s2, 3
    s_and_b32 s65, s70, 1
    s_lshl_b32 s65, s65, 3
    s_and_b32 s72, s71, 7
    s_add_u32 s65, s65, s72
    s_lshr_b32 s66, s70, 1
    s_lshl_b32 s66, s66, 2
    s_lshr_b32 s72, s71, 3
    s_add_u32 s66, s66, s72
    v_lshrrev_b32 v32, 3, v1
    v_and_b32 v33, 7, v1
    v_and_b32 v34, 6, v32
    v_xor_b32 v33, v33, v34
    v_lshlrev_b32 v33, 4, v33
    v_and_b32 v34, 4, v32
    v_add_u32 v34, v34, v32
    v_mul_u32_u24 v13, 1280, v34
    v_add_u32 v13, v13, v33
    v_mul_u32_u24 v11, 1280, v32
    v_add_u32 v11, v11, v33
    v_add_u32 v13, 4096, v13
    v_add_u32 v14, 19456, v13
    v_add_u32 v15, -1920, v13
    v_add_u32 v16, 17536, v13
    s_mul_i32 s72, s66, 80
    v_min_u32 v35, 39, v1
    v_lshlrev_b32 v35, 1, v35
    v_add_u32 v35, s72, v35
    s_lshl_b32 s74, s65, 2
    s_add_u32 s74, s74, s64
    s_mul_i32 s74, s74, 40960
    s_mul_i32 s92, s64, 20480
    s_add_u32 s97, s65, s66
    s_mul_i32 s98, s97, 52
    s_lshr_b32 s98, s98, 8
    s_mul_i32 s98, s98, 5
    s_sub_u32 s97, s97, s98
    s_lshl_b32 s97, s97, 8
    s_waitcnt lgkmcnt(0)
    global_load_ushort v36, v35, s[6:7]
    global_load_ushort v37, v35, s[8:9]
    global_load_ushort v38, v35, s[18:19]
    s_sub_u32 s36, s4, 4096
    s_subb_u32 s37, s5, 0
    s_and_b32 s37, s37, 0xffff
    s_mov_b32 s38, 2625536
    s_mov_b32 s39, 0x20000
    s_mov_b32 s60, s32
    s_and_b32 s61, s33, 0xffff
    s_mov_b32 s62, 256
    s_mov_b32 s63, 0x20000
    s_add_u32 s22, s97, 0
    s_cmp_ge_u32 s22, 1280
    s_cselect_b32 s98, 1280, 0
    s_sub_u32 s22, s22, s98
    s_add_u32 m0, s92, 0
    s_add_u32 s5, s22, s74
    buffer_load_dwordx4 v13, s[36:39], s5 offen offset:0  lds
    buffer_load_dwordx4 v14, s[36:39], s5 offen offset:1024  lds
    buffer_load_dwordx4 v15, s[36:39], s5 offen offset:2048  lds
    buffer_load_dwordx4 v16, s[36:39], s5 offen offset:3072  lds
    s_mov_b32 s48, s34
    s_and_b32 s49, s35, 0xffff
    s_mov_b32 s50, 16777216
    s_mov_b32 s51, 0x20000
    s_or_b32 s72, s2, s64
    s_cmp_eq_u32 s72, 0
    s_mov_b32 s73, 16068608
    s_cselect_b32 s19, s73, 1073741824
    buffer_load_dword v39, off, s[48:51], s19 sc1
    s_add_u32 s23, s97, 256
    s_cmp_ge_u32 s23, 1280
    s_cselect_b32 s98, 1280, 0
    s_sub_u32 s23, s23, s98
    s_add_u32 m0, s92, 4096
    s_add_u32 s5, s23, s74
    buffer_load_dwordx4 v13, s[36:39], s5 offen offset:0  lds
    buffer_load_dwordx4 v14, s[36:39], s5 offen offset:1024  lds
    buffer_load_dwordx4 v15, s[36:39], s5 offen offset:2048  lds
    buffer_load_dwordx4 v16, s[36:39], s5 offen offset:3072  lds
    s_add_u32 s0, s97, 512
    s_cmp_ge_u32 s0, 1280
    s_cselect_b32 s98, 1280, 0
    s_sub_u32 s0, s0, s98
    s_add_u32 s1, s97, 768
    s_cmp_ge_u32 s1, 1280
    s_cselect_b32 s98, 1280, 0
    s_sub_u32 s1, s1, s98
    s_add_u32 s32, s97, 1024
    s_cmp_ge_u32 s32, 1280
    s_cselect_b32 s98, 1280, 0
    s_sub_u32 s32, s32, s98
    v_and_b32 v40, 15, v1
    v_lshrrev_b32 v41, 4, v1
    v_and_b32 v42, 7, v40
    v_and_b32 v43, 6, v40
    v_xor_b32 v43, v43, v41
    v_lshlrev_b32 v43, 4, v43
    v_lshl_add_u32 v43, v42, 7, v43
    v_lshrrev_b32 v42, 3, v40
    v_mul_u32_u24 v5, 5120, v42
    v_add_u32 v5, v5, v43
    v_xor_b32 v6, 64, v5
    v_lshl_add_u32 v3, v42, 10, v43
    v_add_u32 v3, s92, v3
    v_xor_b32 v4, 64, v3
    v_add_u32 v12, 4096, v2
    v_mov_b32 v50, 0x3f803f80
    v_accvgpr_write_b32 a216, v50
    v_accvgpr_write_b32 a217, v50
    v_accvgpr_write_b32 a218, v50
    v_accvgpr_write_b32 a219, v50
    v_add_u32 v27, 9216, v11
    v_add_u32 v28, 18432, v11
    v_add_u32 v29, 27648, v11
    s_bitcmp1_b32 s64, 0
    s_cselect_b32 s40, s12, s10
    s_cselect_b32 s41, s13, s11
    s_cselect_b32 s44, s26, s24
    s_cselect_b32 s45, s27, s25
    s_and_b32 s41, s41, 0xffff
    s_and_b32 s45, s45, 0xffff
    s_mov_b32 s42, 819200
    s_mov_b32 s43, 0x20000
    s_mov_b32 s46, 1966080
    s_mov_b32 s47, 0x20000
    s_mov_b32 s52, s30
    s_and_b32 s53, s31, 0xffff
    s_mov_b32 s54, 5242880
    s_mov_b32 s55, 0x20000
    s_and_b32 s67, s70, 3
    s_lshl_b32 s67, s67, 3
    s_and_b32 s72, s71, 7
    s_add_u32 s67, s67, s72
    s_lshr_b32 s68, s70, 2
    s_lshl_b32 s68, s68, 2
    s_lshr_b32 s72, s71, 3
    s_add_u32 s68, s68, s72
    s_mul_i32 s75, s66, 51200
    s_lshr_b32 s72, s64, 1
    s_lshl_b32 s72, s72, 7
    s_add_u32 s75, s75, s72
    s_mul_i32 s18, s64, 5120
    s_mul_i32 s72, s66, 192
    s_bitcmp1_b32 s66, 0
    s_cselect_b32 s73, 64, 0
    s_cselect_b32 s97, 0, 128
    s_add_u32 s76, s72, s73
    s_add_u32 s77, s72, s97
    s_lshr_b32 s72, s64, 1
    s_mul_i32 s73, s72, 98304
    s_add_u32 s76, s76, s73
    s_mul_i32 s73, s72, 196608
    s_add_u32 s77, s77, s73
    s_lshl_b32 s93, s64, 12
    s_lshl_b32 s73, s65, 1
    s_add_u32 s73, s73, s72
    s_mul_i32 s80, s73, 360448
    s_and_b32 s73, s64, 1
    s_lshl_b32 s73, s73, 11
    s_add_u32 s80, s80, s73
    s_mul_i32 s73, s66, 3
    s_add_u32 s73, s73, 40
    s_and_b32 s97, s66, 1
    s_add_u32 s81, s73, s97
    s_lshl_b32 s81, s81, 12
    s_add_u32 s81, s81, s80
    s_xor_b32 s97, s97, 1
    s_lshl_b32 s97, s97, 1
    s_add_u32 s82, s73, s97
    s_lshl_b32 s82, s82, 12
    s_add_u32 s82, s82, s80
    s_lshl_b32 s73, s66, 4
    s_add_u32 s97, s73, s65
    s_mul_i32 s97, s97, 640
    s_add_u32 s97, s97, 15728640
    s_cmp_eq_u32 s64, 3
    s_cselect_b32 s83, s97, 1073741824
    s_lshl_b32 s97, s64, 2
    s_add_u32 s97, s97, s65
    s_add_i32 s97, s97, -16
    s_add_u32 s98, s73, s97
    s_mul_i32 s98, s98, 640
    s_add_u32 s98, s98, 15728640
    s_cmp_ge_i32 s97, 0
    s_cselect_b32 s84, s98, 1073741824
    s_lshl_b32 s97, s64, 2
    s_add_u32 s97, s97, s65
    s_add_i32 s97, s97, -15
    s_add_u32 s98, s73, s97
    s_mul_i32 s98, s98, 640
    s_add_u32 s98, s98, 15728640
    s_cmp_ge_i32 s97, 0
    s_cselect_b32 s85, s98, 1073741824
    s_lshl_b32 s97, s64, 2
    s_add_u32 s97, s97, s65
    s_add_i32 s97, s97, -14
    s_add_u32 s98, s73, s97
    s_mul_i32 s98, s98, 640
    s_add_u32 s98, s98, 15728640
    s_cmp_ge_i32 s97, 0
    s_cselect_b32 s86, s98, 1073741824
    s_lshl_b32 s97, s64, 2
    s_add_u32 s97, s97, s65
    s_add_i32 s97, s97, -13
    s_add_u32 s98, s73, s97
    s_mul_i32 s98, s98, 640
    s_add_u32 s98, s98, 15728640
    s_cmp_ge_i32 s97, 0
    s_cselect_b32 s87, s98, 1073741824
    s_lshl_b32 s73, s65, 2
    s_add_u32 s73, s73, s64
    s_lshl_b32 s73, s73, 8
    s_add_u32 s73, s73, 15990784
    s_cmp_eq_u32 s66, 0
    s_cselect_b32 s99, s73, 1073741824
    s_mul_i32 s72, s66, 5
    s_add_u32 s72, s72, 0
    s_and_b32 s97, s72, 3
    s_lshr_b32 s72, s72, 2
    s_lshl_b32 s72, s72, 12
    s_lshl_b32 s97, s97, 8
    s_add_u32 s72, s72, s97
    s_add_u32 s24, s72, s80
    s_mul_i32 s72, s66, 5
    s_add_u32 s72, s72, 1
    s_and_b32 s97, s72, 3
    s_lshr_b32 s72, s72, 2
    s_lshl_b32 s72, s72, 12
    s_lshl_b32 s97, s97, 8
    s_add_u32 s72, s72, s97
    s_add_u32 s25, s72, s80
    s_mul_i32 s72, s66, 5
    s_add_u32 s72, s72, 2
    s_and_b32 s97, s72, 3
    s_lshr_b32 s72, s72, 2
    s_lshl_b32 s72, s72, 12
    s_lshl_b32 s97, s97, 8
    s_add_u32 s72, s72, s97
    s_add_u32 s26, s72, s80
    s_mul_i32 s72, s66, 5
    s_add_u32 s72, s72, 3
    s_and_b32 s97, s72, 3
    s_lshr_b32 s72, s72, 2
    s_lshl_b32 s72, s72, 12
    s_lshl_b32 s97, s97, 8
    s_add_u32 s72, s72, s97
    s_add_u32 s27, s72, s80
    s_mul_i32 s72, s66, 5
    s_add_u32 s72, s72, 4
    s_and_b32 s97, s72, 3
    s_lshr_b32 s72, s72, 2
    s_lshl_b32 s72, s72, 12
    s_lshl_b32 s97, s97, 8
    s_add_u32 s72, s72, s97
    s_add_u32 s30, s72, s80
    s_mul_i32 s95, s67, 360448
    s_mul_i32 s96, s68, 450560
    s_add_u32 s96, s96, 11534336
    s_mul_i32 s9, s64, 49152
    s_add_u32 s9, s9, s95
    s_add_u32 s9, s9, 163840
    s_mul_i32 s10, s64, 40960
    s_add_u32 s10, s10, s95
    s_mul_i32 s12, s64, 61440
    s_add_u32 s12, s12, s96
    s_add_u32 s12, s12, 204800
    s_mul_i32 s13, s64, 51200
    s_add_u32 s13, s13, s96
    s_lshl_b32 s72, s64, 13
    s_add_u32 s72, s72, 122880
    v_and_b32 v51, 15, v1
    v_lshrrev_b32 v52, 4, v1
    v_lshl_add_u32 v19, v51, 4, s72
    v_lshl_add_u32 v17, v52, 2, v19
    v_min_u32 v53, 39, v1
    v_lshlrev_b32 v26, 4, v53
    v_lshrrev_b32 v54, 3, v53
    v_lshlrev_b32 v54, 3, v54
    v_add_u32 v54, v54, v53
    v_lshl_add_u32 v18, v54, 4, s72
    v_add_u32 v20, s72, v2
    s_lshl_b32 s73, s64, 9
    s_add_u32 s73, s73, 155648
    v_lshl_add_u32 v21, v1, 3, s73
    v_lshlrev_b32 v22, 5, v1
    v_add_u32 v22, 159744, v22
    s_add_u32 s73, s18, 102400
    v_lshlrev_b32 v23, 5, v51
    v_lshl_add_u32 v23, v52, 3, v23
    v_add_u32 v23, s73, v23
    v_bfe_u32 v54, v1, 2, 2
    v_lshlrev_b32 v54, 5, v54
    v_lshl_add_u32 v54, v52, 8, v54
    v_and_b32 v53, 3, v1
    s_waitcnt vmcnt(7)
    ds_read_b128 v[96:99], v3 offset:0
    ds_read_b128 v[100:103], v4 offset:0
    s_add_u32 m0, s92, 8192
    s_add_u32 s5, s0, s74
    buffer_load_dwordx4 v13, s[36:39], s5 offen offset:0  lds
    buffer_load_dwordx4 v14, s[36:39], s5 offen offset:1024  lds
    v_lshl_add_u32 v54, v53, 3, v54
    v_add_u32 v24, s73, v54
    v_lshrrev_b32 v54, 1, v52
    v_lshlrev_b32 v54, 10, v54
    v_lshl_add_u32 v25, v51, 4, v54
    v_and_b32 v54, 1, v52
    v_mul_u32_u24 v54, 81920, v54
    v_add_u32 v25, v25, v54
    v_lshrrev_b32 v51, 4, v1
    v_bfe_u32 v52, v1, 2, 2
    v_and_b32 v53, 3, v1
    v_lshrrev_b32 v54, 1, v51
    v_lshlrev_b32 v54, 11, v54
    v_lshl_add_u32 v54, v52, 7, v54
    v_and_b32 v55, 1, v53
    v_lshl_add_u32 v54, v55, 3, v54
    v_and_b32 v55, 1, v51
    v_lshlrev_b32 v55, 1, v55
    v_lshrrev_b32 v8, 1, v53
    v_add_u32 v55, v55, v8
    v_lshrrev_b32 v8, 1, v52
    v_lshlrev_b32 v8, 2, v8
    v_xor_b32 v55, v55, v8
    v_lshl_add_u32 v7, v55, 4, v54
    v_xor_b32 v8, 64, v7
    v_lshrrev_b32 v54, 1, v51
    v_lshlrev_b32 v54, 10, v54
    v_lshl_add_u32 v54, v52, 6, v54
    v_and_b32 v55, 1, v51
    s_waitcnt vmcnt(7)
    ds_read_b128 v[104:107], v3 offset:2048
    ds_read_b128 v[108:111], v4 offset:2048
    buffer_load_dwordx4 v15, s[36:39], s5 offen offset:2048  lds
    buffer_load_dwordx4 v16, s[36:39], s5 offen offset:3072  lds
    s_waitcnt lgkmcnt(2)
    v_mfma_f32_16x16x32_bf16 a[220:223], a[216:219], v[96:99], 0
    v_mfma_f32_16x16x32_bf16 a[224:227], v[96:99], v[96:99], 0
    v_mfma_f32_16x16x32_bf16 a[220:223], a[216:219], v[100:103], a[220:223]
    v_mfma_f32_16x16x32_bf16 a[224:227], v[100:103], v[100:103], a[224:227]
    v_lshl_add_u32 v54, v55, 5, v54
    v_lshl_add_u32 v9, v53, 3, v54
    v_lshlrev_b32 v55, 10, v55
    v_lshrrev_b32 v54, 1, v51
    v_lshl_add_u32 v55, v54, 8, v55
    v_and_b32 v54, 15, v1
    v_lshl_add_u32 v10, v54, 4, v55
    v_lshlrev_b32 v36, 16, v36
    v_lshlrev_b32 v37, 16, v37
    v_lshlrev_b32 v38, 16, v38
    v_mul_f32 v72, 0x3fb8aa3b, v38
    v_exp_f32 v72, v72
    s_nop 0
    v_cvt_pk_bf16_f32 v72, v72, v72
    v_lshlrev_b32 v72, 16, v72
    v_mul_f32 v73, v72, v36
    v_mul_f32 v74, v72, v37
    v_mul_f32 v73, 0x3fb8aa3b, v73
    v_exp_f32 v73, v73
    v_mul_f32 v74, 0.15915494, v74
    v_rndne_f32 v75, v74
    v_sub_f32 v74, v74, v75
    v_cos_f32 v75, v74
    v_sin_f32 v76, v74
    v_mul_f32 v56, v73, v75
    v_mul_f32 v57, v73, v76
    v_add_f32 v75, -1.0, v56
    v_mul_f32 v77, v36, v36
    v_fmac_f32 v77, v37, v37
    v_rcp_f32 v77, v77
    s_waitcnt vmcnt(6)
    ds_read_b128 v[112:115], v3 offset:4096
    ds_read_b128 v[116:119], v4 offset:4096
    s_add_u32 m0, s92, 12288
    s_add_u32 s5, s1, s74
    buffer_load_dwordx4 v13, s[36:39], s5 offen offset:0  lds
    buffer_load_dwordx4 v14, s[36:39], s5 offen offset:1024  lds
    s_waitcnt lgkmcnt(2)
    v_mfma_f32_16x16x32_bf16 a[220:223], a[216:219], v[104:107], a[220:223]
    v_mfma_f32_16x16x32_bf16 a[224:227], v[104:107], v[104:107], a[224:227]
    v_mfma_f32_16x16x32_bf16 a[220:223], a[216:219], v[108:111], a[220:223]
    v_mfma_f32_16x16x32_bf16 a[224:227], v[108:111], v[108:111], a[224:227]
    v_mul_f32 v78, v75, v36
    v_fmac_f32 v78, v57, v37
    v_mul_f32 v79, v57, v36
    v_fma_f32 v79, -v75, v37, v79
    v_add_f32 v77, v77, v77
    v_mul_f32 v58, v78, v77
    v_mul_f32 v59, v79, v77
    v_mov_b32 v80, v56
    v_sub_f32 v81, 0, v57
    v_mul_f32 v72, v81, v81
    v_mul_f32 v83, v80, v81
    v_fma_f32 v82, v80, v80, -v72
    v_add_f32 v83, v83, v83
    v_mul_f32 v72, v83, v83
    v_mul_f32 v81, v82, v83
    v_fma_f32 v80, v82, v82, -v72
    v_add_f32 v81, v81, v81
    v_mul_f32 v72, v81, v81
    v_mul_f32 v61, v80, v81
    v_fma_f32 v60, v80, v80, -v72
    v_add_f32 v61, v61, v61
    v_mul_f32 v72, v61, v61
    v_mul_f32 v81, v60, v61
    v_fma_f32 v80, v60, v60, -v72
    v_add_f32 v81, v81, v81
    v_mul_f32 v72, v81, v81
    v_mul_f32 v63, v80, v81
    v_fma_f32 v62, v80, v80, -v72
    v_add_f32 v63, v63, v63
    s_waitcnt vmcnt(6)
    ds_read_b128 v[120:123], v3 offset:6144
    ds_read_b128 v[124:127], v4 offset:6144
    buffer_load_dwordx4 v15, s[36:39], s5 offen offset:2048  lds
    buffer_load_dwordx4 v16, s[36:39], s5 offen offset:3072  lds
    s_waitcnt lgkmcnt(2)
    v_mfma_f32_16x16x32_bf16 a[220:223], a[216:219], v[112:115], a[220:223]
    v_mfma_f32_16x16x32_bf16 a[224:227], v[112:115], v[112:115], a[224:227]
    v_mfma_f32_16x16x32_bf16 a[220:223], a[216:219], v[116:119], a[220:223]
    v_mfma_f32_16x16x32_bf16 a[224:227], v[116:119], v[116:119], a[224:227]
    v_mul_f32 v72, v63, v63
    v_mul_f32 v85, v62, v63
    v_fma_f32 v84, v62, v62, -v72
    v_add_f32 v85, v85, v85
    v_mul_f32 v72, v85, v85
    v_mul_f32 v67, v84, v85
    v_fma_f32 v66, v84, v84, -v72
    v_add_f32 v67, v67, v67
    v_mul_f32 v72, v67, v67
    v_mul_f32 v81, v66, v67
    v_fma_f32 v80, v66, v66, -v72
    v_add_f32 v81, v81, v81
    v_mul_f32 v72, v81, v81
    v_mul_f32 v87, v80, v81
    v_fma_f32 v86, v80, v80, -v72
    v_add_f32 v87, v87, v87
    v_mul_f32 v72, v87, v87
    v_mul_f32 v89, v86, v87
    v_fma_f32 v88, v86, v86, -v72
    v_add_f32 v89, v89, v89
    s_bitcmp1_b32 s64, 0
    s_cselect_b64 s[88:89], -1, 0
    s_bitcmp1_b32 s64, 1
    s_cselect_b64 s[90:91], -1, 0
    v_cndmask_b32 v90, 1.0, v62, s[88:89]
    v_cndmask_b32 v91, 0, v63, s[88:89]
    v_cndmask_b32 v92, 1.0, v84, s[90:91]
    v_cndmask_b32 v93, 0, v85, s[90:91]
    v_mul_f32 v72, v91, v93
    s_waitcnt vmcnt(6)
    ds_read_b128 v[128:131], v3 offset:8192
    ds_read_b128 v[132:135], v4 offset:8192
    s_add_u32 m0, s92, 16384
    s_add_u32 s5, s32, s74
    buffer_load_dwordx4 v13, s[36:39], s5 offen offset:0  lds
    buffer_load_dwordx4 v14, s[36:39], s5 offen offset:1024  lds
    s_waitcnt lgkmcnt(2)
    v_mfma_f32_16x16x32_bf16 a[220:223], a[216:219], v[120:123], a[220:223]
    v_mfma_f32_16x16x32_bf16 a[224:227], v[120:123], v[120:123], a[224:227]
    v_mfma_f32_16x16x32_bf16 a[220:223], a[216:219], v[124:127], a[220:223]
    v_mfma_f32_16x16x32_bf16 a[224:227], v[124:127], v[124:127], a[224:227]
    v_mul_f32 v65, v91, v92
    v_fma_f32 v64, v90, v92, -v72
    v_fmac_f32 v65, v90, v93
    v_mov_b32 v94, 1.0
    v_mov_b32 v95, 0
    v_cndmask_b32 v90, v86, v94, s[88:89]
    v_cndmask_b32 v91, v87, v95, s[88:89]
    v_mov_b32 v94, 1.0
    v_mov_b32 v95, 0
    v_cndmask_b32 v92, v88, v94, s[90:91]
    v_cndmask_b32 v93, v89, v95, s[90:91]
    v_mul_f32 v72, v91, v93
    v_mul_f32 v69, v91, v92
    v_fma_f32 v68, v90, v92, -v72
    v_fmac_f32 v69, v90, v93
    v_accvgpr_write_b32 a200, v56
    v_accvgpr_write_b32 a201, v57
    v_accvgpr_write_b32 a202, v58
    v_accvgpr_write_b32 a203, v59
    v_accvgpr_write_b32 a204, v60
    v_accvgpr_write_b32 a205, v61
    v_accvgpr_write_b32 a206, v62
    v_accvgpr_write_b32 a207, v63
    v_accvgpr_write_b32 a208, v64
    v_accvgpr_write_b32 a209, v65
    v_accvgpr_write_b32 a210, v66
    v_accvgpr_write_b32 a211, v67
    v_accvgpr_write_b32 a212, v68
    s_waitcnt vmcnt(6)
    ds_read_b128 v[136:139], v3 offset:10240
    ds_read_b128 v[140:143], v4 offset:10240
    buffer_load_dwordx4 v15, s[36:39], s5 offen offset:2048  lds
    buffer_load_dwordx4 v16, s[36:39], s5 offen offset:3072  lds
    s_waitcnt lgkmcnt(2)
    v_mfma_f32_16x16x32_bf16 a[220:223], a[216:219], v[128:131], a[220:223]
    v_mfma_f32_16x16x32_bf16 a[224:227], v[128:131], v[128:131], a[224:227]
    v_mfma_f32_16x16x32_bf16 a[220:223], a[216:219], v[132:135], a[220:223]
    v_mfma_f32_16x16x32_bf16 a[224:227], v[132:135], v[132:135], a[224:227]
    v_accvgpr_write_b32 a213, v69
    s_mov_b32 s72, 1664525
    v_mul_lo_u32 v39, v39, s72
    v_add_u32 v30, 1013904223, v39
    v_mov_b32 v31, 1
    buffer_store_dword v30, off, s[48:51], s19 sc1
    s_lshl_b32 s72, s64, 5
    s_add_u32 s72, s72, s67
    s_mul_i32 s73, s68, 88
    s_add_u32 s73, s73, s72
    s_mul_i32 s73, s73, 5120
    s_add_u32 s73, s73, 11534336
    s_cmp_lt_u32 s72, 88
    s_cselect_b32 s79, s73, 1073741824
    s_mov_b32 s59, 0x20000
    s_cmp_lt_u32 s72, 40
    s_waitcnt lgkmcnt(0)
    s_cbranch_scc0 L_rlw
    s_cmp_lt_u32 s72, 20
    s_cselect_b32 s56, s14, s16
    s_cselect_b32 s57, s15, s17
    s_cselect_b32 s73, 0, 20
    s_sub_u32 s73, s72, s73
    s_lshl_b32 s73, s73, 6
    s_mul_i32 s97, s68, 102400
    s_add_u32 s78, s73, s97
    s_mov_b32 s58, 819200
    v_lshrrev_b32 v37, 2, v1
    v_and_b32 v38, 3, v1
    v_lshlrev_b32 v38, 4, v38
    v_mul_u32_u24 v37, 1280, v37
    v_add_u32 v32, v37, v38
    v_add_u32 v33, 20480, v32
    v_add_u32 v34, 40960, v32
    v_add_u32 v35, 61440, v32
    v_add_u32 v36, 81920, v32
    s_branch L_rlj
L_rlw:
    s_mov_b32 s56, s28
    s_mov_b32 s57, s29
    s_cmp_lt_u32 s72, 88
    s_cselect_b32 s58, 1966080, 0
    s_sub_u32 s73, s72, 40
    s_mul_i32 s73, s73, 40960
    s_mul_i32 s97, s68, 160
    s_add_u32 s78, s73, s97
    s_mov_b32 s97, 6554
    v_add_u32 v37, 0, v1
    v_mul_u32_u24 v38, s97, v37
    v_lshrrev_b32 v38, 16, v38
    v_mul_u32_u24 v39, 10, v38
    v_sub_u32 v39, v37, v39
    v_lshlrev_b32 v39, 4, v39
    v_mul_u32_u24 v38, 1280, v38
    v_add_u32 v32, v38, v39
    v_add_u32 v37, 64, v1
    v_mul_u32_u24 v38, s97, v37
    v_lshrrev_b32 v38, 16, v38
    v_mul_u32_u24 v39, 10, v38
    v_sub_u32 v39, v37, v39
    v_lshlrev_b32 v39, 4, v39
    v_mul_u32_u24 v38, 1280, v38
    v_add_u32 v33, v38, v39
    v_add_u32 v37, 128, v1
    v_mul_u32_u24 v38, s97, v37
    v_lshrrev_b32 v38, 16, v38
    v_mul_u32_u24 v39, 10, v38
    v_sub_u32 v39, v37, v39
    v_lshlrev_b32 v39, 4, v39
    v_mul_u32_u24 v38, 1280, v38
    v_add_u32 v34, v38, v39
    v_add_u32 v37, 192, v1
    v_mul_u32_u24 v38, s97, v37
    v_lshrrev_b32 v38, 16, v38
    v_mul_u32_u24 v39, 10, v38
    v_sub_u32 v39, v37, v39
    v_lshlrev_b32 v39, 4, v39
    v_mul_u32_u24 v38, 1280, v38
    v_add_u32 v35, v38, v39
    v_add_u32 v37, 256, v1
    v_mul_u32_u24 v38, s97, v37
    v_lshrrev_b32 v38, 16, v38
    v_mul_u32_u24 v39, 10, v38
    v_sub_u32 v39, v37, v39
    v_lshlrev_b32 v39, 4, v39
    v_mul_u32_u24 v38, 1280, v38
    v_add_u32 v36, v38, v39
L_rlj:
    s_waitcnt vmcnt(7)
    ds_read_b128 v[144:147], v3 offset:12288
    ds_read_b128 v[148:151], v4 offset:12288
    s_add_u32 m0, s92, 81920
    s_add_u32 s5, s22, s74
    s_add_u32 s5, s5, 5120
    buffer_load_dwordx4 v13, s[36:39], s5 offen offset:0  lds
    buffer_load_dwordx4 v14, s[36:39], s5 offen offset:1024  lds
    v_mfma_f32_16x16x32_bf16 a[220:223], a[216:219], v[136:139], a[220:223]
    v_mfma_f32_16x16x32_bf16 a[224:227], v[136:139], v[136:139], a[224:227]
    v_mfma_f32_16x16x32_bf16 a[220:223], a[216:219], v[140:143], a[220:223]
    v_mfma_f32_16x16x32_bf16 a[224:227], v[140:143], v[140:143], a[224:227]
    s_waitcnt vmcnt(7)
    ds_read_b128 v[152:155], v3 offset:14336
    ds_read_b128 v[156:159], v4 offset:14336
    buffer_load_dwordx4 v15, s[36:39], s5 offen offset:2048  lds
    buffer_load_dwordx4 v16, s[36:39], s5 offen offset:3072  lds
    s_waitcnt lgkmcnt(2)
    v_mfma_f32_16x16x32_bf16 a[220:223], a[216:219], v[144:147], a[220:223]
    v_mfma_f32_16x16x32_bf16 a[224:227], v[144:147], v[144:147], a[224:227]
    v_mfma_f32_16x16x32_bf16 a[220:223], a[216:219], v[148:151], a[220:223]
    v_mfma_f32_16x16x32_bf16 a[224:227], v[148:151], v[148:151], a[224:227]
    s_waitcnt vmcnt(7)
    ds_read_b128 v[160:163], v3 offset:16384
    ds_read_b128 v[164:167], v4 offset:16384
    s_add_u32 m0, s92, 86016
    s_add_u32 s5, s23, s74
    s_add_u32 s5, s5, 5120
    buffer_load_dwordx4 v13, s[36:39], s5 offen offset:0  lds
    buffer_load_dwordx4 v14, s[36:39], s5 offen offset:1024  lds
    s_waitcnt lgkmcnt(2)
    v_mfma_f32_16x16x32_bf16 a[220:223], a[216:219], v[152:155], a[220:223]
    v_mfma_f32_16x16x32_bf16 a[224:227], v[152:155], v[152:155], a[224:227]
    v_mfma_f32_16x16x32_bf16 a[220:223], a[216:219], v[156:159], a[220:223]
    v_mfma_f32_16x16x32_bf16 a[224:227], v[156:159], v[156:159], a[224:227]
    s_and_b32 s57, s57, 0xffff
    v_accvgpr_write_b32 a232, v32
    v_accvgpr_write_b32 a233, v33
    v_accvgpr_write_b32 a234, v34
    v_accvgpr_write_b32 a235, v35
    v_accvgpr_write_b32 a236, v36
    v_and_b32 v37, 15, v1
    v_lshrrev_b32 v38, 4, v1
    v_lshlrev_b32 v38, 4, v38
    v_lshl_add_u32 v37, v37, 6, v38
    v_lshrrev_b32 v38, 2, v1
    v_and_b32 v39, 8, v38
    v_add_u32 v38, v38, v39
    v_mul_u32_u24 v38, 160, v38
    v_and_b32 v39, 3, v1
    v_lshl_add_u32 v38, v39, 3, v38
    s_lshl_b32 s72, s64, 5
    s_add_u32 s72, s72, s67
    s_cmp_lt_u32 s72, 40
    s_cselect_b64 s[88:89], -1, 0
    s_cselect_b32 s33, 1, 0
    s_add_u32 s73, s18, 102400
    v_cndmask_b32 v37, v38, v37, s[88:89]
    v_add_u32 v37, s73, v37
    v_accvgpr_write_b32 a237, v37
    s_sub_u32 s77, s77, s76
    s_waitcnt vmcnt(7)
    ds_read_b128 v[168:171], v3 offset:18432
    ds_read_b128 v[172:175], v4 offset:18432
    buffer_load_dwordx4 v15, s[36:39], s5 offen offset:2048  lds
    buffer_load_dwordx4 v16, s[36:39], s5 offen offset:3072  lds
    s_waitcnt lgkmcnt(2)
    v_mfma_f32_16x16x32_bf16 a[220:223], a[216:219], v[160:163], a[220:223]
    v_mfma_f32_16x16x32_bf16 a[224:227], v[160:163], v[160:163], a[224:227]
    v_mfma_f32_16x16x32_bf16 a[220:223], a[216:219], v[164:167], a[220:223]
    v_mfma_f32_16x16x32_bf16 a[224:227], v[164:167], v[164:167], a[224:227]
    s_mul_i32 s14, s22, 1536
    s_add_u32 s14, s14, s76
    s_mul_i32 s15, s23, 1536
    s_add_u32 s15, s15, s76
    s_mul_i32 s16, s0, 1536
    s_add_u32 s16, s16, s76
    s_mul_i32 s17, s1, 1536
    s_add_u32 s17, s17, s76
    s_mul_i32 s28, s32, 1536
    s_add_u32 s28, s28, s76
    s_lshl_b32 s72, s68, 7
    s_lshl_b32 s73, s67, 2
    s_add_u32 s72, s72, s73
    s_add_u32 s72, s72, 16056320
    s_lshl_b32 s73, s65, 7
    s_lshl_b32 s97, s66, 2
    s_add_u32 s73, s73, s97
    s_cmp_eq_u32 s64, 0
    s_cselect_b32 s29, s72, 1073741824
    s_cselect_b32 s73, s73, 1073741824
    s_add_u32 s34, s73, 16072704
    s_add_u32 s35, s73, 16064512
    s_add_u32 s6, s73, 16060416
    s_lshr_b32 s7, s67, 1
    s_lshl_b32 s7, s7, 7
    v_min_u32 v32, 9, v1
    v_lshlrev_b32 v32, 7, v32
    global_load_dword a231, v32, s[20:21]
    s_waitcnt lgkmcnt(0)
    s_barrier
    v_mfma_f32_16x16x32_bf16 a[220:223], a[216:219], v[168:171], a[220:223]
    v_mfma_f32_16x16x32_bf16 a[224:227], v[168:171], v[168:171], a[224:227]
    v_mfma_f32_16x16x32_bf16 a[220:223], a[216:219], v[172:175], a[220:223]
    v_mfma_f32_16x16x32_bf16 a[224:227], v[172:175], v[172:175], a[224:227]
    v_and_b32 v51, 15, v1
    v_lshrrev_b32 v52, 2, v51
    v_lshl_add_u32 v52, v52, 4, v51
    v_lshlrev_b32 v52, 2, v52
    v_and_b32 v51, 3, v1
    v_cmp_eq_u32 s[88:89], 1, v51
    v_cmp_eq_u32 s[90:91], 2, v51
    v_cmp_eq_u32 vcc, 3, v51
    v_accvgpr_read_b32 v40, a224
    v_accvgpr_read_b32 v41, a225
    v_accvgpr_read_b32 v42, a226
    v_accvgpr_read_b32 v43, a227
    v_cndmask_b32 v40, v40, v41, s[88:89]
    v_cndmask_b32 v42, v42, v43, vcc
    v_cndmask_b32 v40, v40, v42, s[90:91]
    v_cndmask_b32 v40, v40, v42, vcc
    ds_bpermute_b32 v42, v52, v40
    v_accvgpr_read_b32 v40, a220
    v_mul_f32 v40, 0x3acccccd, v40
    s_waitcnt lgkmcnt(0)
    v_mul_f32 v42, 0x3acccccd, v42
    v_fma_f32 v42, -v40, v40, v42
    v_max_f32 v42, 0, v42
    v_cvt_pk_bf16_f32 v51, v40, v42
    v_lshlrev_b32 v48, 16, v51
    v_and_b32 v52, 0xffff0000, v51
    v_add_f32 v52, 0x3727c5ac, v52
    v_cvt_pk_bf16_f32 v52, v52, v52
    v_and_b32 v52, 0xffff0000, v52
    v_sqrt_f32 v52, v52
    s_nop 0
    v_cvt_pk_bf16_f32 v52, v52, v52
    v_and_b32 v52, 0xffff0000, v52
    v_rcp_f32 v44, v52
    s_nop 0
    v_mul_f32 v45, v48, v44
    v_sub_f32 v45, 0, v45
    v_add_u32 v3, 81920, v3
    v_add_u32 v4, 81920, v4
    s_waitcnt vmcnt(7)
    ds_read_b128 v[176:179], v3 offset:0
    ds_read_b128 v[180:183], v4 offset:0
    s_add_u32 m0, s92, 90112
    s_add_u32 s5, s0, s74
    s_add_u32 s5, s5, 5120
    buffer_load_dwordx4 v13, s[36:39], s5 offen offset:0  lds
    buffer_load_dwordx4 v14, s[36:39], s5 offen offset:1024  lds
    v_lshlrev_b32 v52, 16, v96
    v_and_b32 v53, 0xffff0000, v96
    v_pk_fma_f32 v[52:53], v[52:53], v[44:45], v[44:45] op_sel:[0,0,1] op_sel_hi:[1,0,1]
    v_cvt_pk_bf16_f32 v96, v52, v53
    v_lshlrev_b32 v54, 16, v97
    v_and_b32 v55, 0xffff0000, v97
    v_pk_fma_f32 v[54:55], v[54:55], v[44:45], v[44:45] op_sel:[0,0,1] op_sel_hi:[1,0,1]
    v_cvt_pk_bf16_f32 v97, v54, v55
    v_lshlrev_b32 v52, 16, v98
    v_and_b32 v53, 0xffff0000, v98
    v_pk_fma_f32 v[52:53], v[52:53], v[44:45], v[44:45] op_sel:[0,0,1] op_sel_hi:[1,0,1]
    v_cvt_pk_bf16_f32 v98, v52, v53
    v_lshlrev_b32 v54, 16, v99
    v_and_b32 v55, 0xffff0000, v99
    v_pk_fma_f32 v[54:55], v[54:55], v[44:45], v[44:45] op_sel:[0,0,1] op_sel_hi:[1,0,1]
    v_cvt_pk_bf16_f32 v99, v54, v55
    v_lshlrev_b32 v52, 16, v100
    v_and_b32 v53, 0xffff0000, v100
    v_pk_fma_f32 v[52:53], v[52:53], v[44:45], v[44:45] op_sel:[0,0,1] op_sel_hi:[1,0,1]
    v_cvt_pk_bf16_f32 v100, v52, v53
    v_lshlrev_b32 v54, 16, v101
    v_and_b32 v55, 0xffff0000, v101
    v_pk_fma_f32 v[54:55], v[54:55], v[44:45], v[44:45] op_sel:[0,0,1] op_sel_hi:[1,0,1]
    v_cvt_pk_bf16_f32 v101, v54, v55
    v_lshlrev_b32 v52, 16, v102
    v_and_b32 v53, 0xffff0000, v102
    v_pk_fma_f32 v[52:53], v[52:53], v[44:45], v[44:45] op_sel:[0,0,1] op_sel_hi:[1,0,1]
    v_cvt_pk_bf16_f32 v102, v52, v53
    v_lshlrev_b32 v54, 16, v103
    v_and_b32 v55, 0xffff0000, v103
    v_pk_fma_f32 v[54:55], v[54:55], v[44:45], v[44:45] op_sel:[0,0,1] op_sel_hi:[1,0,1]
    v_cvt_pk_bf16_f32 v103, v54, v55
    s_waitcnt vmcnt(7)
    ds_read_b128 v[184:187], v3 offset:2048
    ds_read_b128 v[188:191], v4 offset:2048
    buffer_load_dwordx4 v15, s[36:39], s5 offen offset:2048  lds
    buffer_load_dwordx4 v16, s[36:39], s5 offen offset:3072  lds
    s_waitcnt lgkmcnt(2)
    v_mfma_f32_16x16x32_bf16 a[220:223], a[216:219], v[176:179], 0
    v_mfma_f32_16x16x32_bf16 a[224:227], v[176:179], v[176:179], 0
    v_mfma_f32_16x16x32_bf16 a[220:223], a[216:219], v[180:183], a[220:223]
    v_mfma_f32_16x16x32_bf16 a[224:227], v[180:183], v[180:183], a[224:227]
    v_lshlrev_b32 v52, 16, v104
    v_and_b32 v53, 0xffff0000, v104
    v_pk_fma_f32 v[52:53], v[52:53], v[44:45], v[44:45] op_sel:[0,0,1] op_sel_hi:[1,0,1]
    v_cvt_pk_bf16_f32 v104, v52, v53
    v_lshlrev_b32 v54, 16, v105
    v_and_b32 v55, 0xffff0000, v105
    v_pk_fma_f32 v[54:55], v[54:55], v[44:45], v[44:45] op_sel:[0,0,1] op_sel_hi:[1,0,1]
    v_cvt_pk_bf16_f32 v105, v54, v55
    v_lshlrev_b32 v52, 16, v106
    v_and_b32 v53, 0xffff0000, v106
    v_pk_fma_f32 v[52:53], v[52:53], v[44:45], v[44:45] op_sel:[0,0,1] op_sel_hi:[1,0,1]
    v_cvt_pk_bf16_f32 v106, v52, v53
    v_lshlrev_b32 v54, 16, v107
    v_and_b32 v55, 0xffff0000, v107
    v_pk_fma_f32 v[54:55], v[54:55], v[44:45], v[44:45] op_sel:[0,0,1] op_sel_hi:[1,0,1]
    v_cvt_pk_bf16_f32 v107, v54, v55
    v_lshlrev_b32 v52, 16, v108
    v_and_b32 v53, 0xffff0000, v108
    v_pk_fma_f32 v[52:53], v[52:53], v[44:45], v[44:45] op_sel:[0,0,1] op_sel_hi:[1,0,1]
    v_cvt_pk_bf16_f32 v108, v52, v53
    v_lshlrev_b32 v54, 16, v109
    v_and_b32 v55, 0xffff0000, v109
    v_pk_fma_f32 v[54:55], v[54:55], v[44:45], v[44:45] op_sel:[0,0,1] op_sel_hi:[1,0,1]
    v_cvt_pk_bf16_f32 v109, v54, v55
    v_lshlrev_b32 v52, 16, v110
    v_and_b32 v53, 0xffff0000, v110
    v_pk_fma_f32 v[52:53], v[52:53], v[44:45], v[44:45] op_sel:[0,0,1] op_sel_hi:[1,0,1]
    v_cvt_pk_bf16_f32 v110, v52, v53
    v_lshlrev_b32 v54, 16, v111
    v_and_b32 v55, 0xffff0000, v111
    v_pk_fma_f32 v[54:55], v[54:55], v[44:45], v[44:45] op_sel:[0,0,1] op_sel_hi:[1,0,1]
    v_cvt_pk_bf16_f32 v111, v54, v55
    s_waitcnt vmcnt(7)
    ds_read_b128 v[192:195], v3 offset:4096
    ds_read_b128 v[196:199], v4 offset:4096
    s_add_u32 m0, s92, 94208
    s_add_u32 s5, s1, s74
    s_add_u32 s5, s5, 5120
    buffer_load_dwordx4 v13, s[36:39], s5 offen offset:0  lds
    buffer_load_dwordx4 v14, s[36:39], s5 offen offset:1024  lds
    s_waitcnt lgkmcnt(2)
    v_mfma_f32_16x16x32_bf16 a[220:223], a[216:219], v[184:187], a[220:223]
    v_mfma_f32_16x16x32_bf16 a[224:227], v[184:187], v[184:187], a[224:227]
    v_mfma_f32_16x16x32_bf16 a[220:223], a[216:219], v[188:191], a[220:223]
    v_mfma_f32_16x16x32_bf16 a[224:227], v[188:191], v[188:191], a[224:227]
    v_lshlrev_b32 v52, 16, v112
    v_and_b32 v53, 0xffff0000, v112
    v_pk_fma_f32 v[52:53], v[52:53], v[44:45], v[44:45] op_sel:[0,0,1] op_sel_hi:[1,0,1]
    v_cvt_pk_bf16_f32 v112, v52, v53
    v_lshlrev_b32 v54, 16, v113
    v_and_b32 v55, 0xffff0000, v113
    v_pk_fma_f32 v[54:55], v[54:55], v[44:45], v[44:45] op_sel:[0,0,1] op_sel_hi:[1,0,1]
    v_cvt_pk_bf16_f32 v113, v54, v55
    v_lshlrev_b32 v52, 16, v114
    v_and_b32 v53, 0xffff0000, v114
    v_pk_fma_f32 v[52:53], v[52:53], v[44:45], v[44:45] op_sel:[0,0,1] op_sel_hi:[1,0,1]
    v_cvt_pk_bf16_f32 v114, v52, v53
    v_lshlrev_b32 v54, 16, v115
    v_and_b32 v55, 0xffff0000, v115
    v_pk_fma_f32 v[54:55], v[54:55], v[44:45], v[44:45] op_sel:[0,0,1] op_sel_hi:[1,0,1]
    v_cvt_pk_bf16_f32 v115, v54, v55
    v_lshlrev_b32 v52, 16, v116
    v_and_b32 v53, 0xffff0000, v116
    v_pk_fma_f32 v[52:53], v[52:53], v[44:45], v[44:45] op_sel:[0,0,1] op_sel_hi:[1,0,1]
    v_cvt_pk_bf16_f32 v116, v52, v53
    v_lshlrev_b32 v54, 16, v117
    v_and_b32 v55, 0xffff0000, v117
    v_pk_fma_f32 v[54:55], v[54:55], v[44:45], v[44:45] op_sel:[0,0,1] op_sel_hi:[1,0,1]
    v_cvt_pk_bf16_f32 v117, v54, v55
    v_lshlrev_b32 v52, 16, v118
    v_and_b32 v53, 0xffff0000, v118
    v_pk_fma_f32 v[52:53], v[52:53], v[44:45], v[44:45] op_sel:[0,0,1] op_sel_hi:[1,0,1]
    v_cvt_pk_bf16_f32 v118, v52, v53
    v_lshlrev_b32 v54, 16, v119
    v_and_b32 v55, 0xffff0000, v119
    v_pk_fma_f32 v[54:55], v[54:55], v[44:45], v[44:45] op_sel:[0,0,1] op_sel_hi:[1,0,1]
    v_cvt_pk_bf16_f32 v119, v54, v55
    s_waitcnt vmcnt(7)
    ds_read_b128 v[200:203], v3 offset:6144
    ds_read_b128 v[204:207], v4 offset:6144
    buffer_load_dwordx4 v15, s[36:39], s5 offen offset:2048  lds
    buffer_load_dwordx4 v16, s[36:39], s5 offen offset:3072  lds
    s_waitcnt lgkmcnt(2)
    v_mfma_f32_16x16x32_bf16 a[220:223], a[216:219], v[192:195], a[220:223]
    v_mfma_f32_16x16x32_bf16 a[224:227], v[192:195], v[192:195], a[224:227]
    v_mfma_f32_16x16x32_bf16 a[220:223], a[216:219], v[196:199], a[220:223]
    v_mfma_f32_16x16x32_bf16 a[224:227], v[196:199], v[196:199], a[224:227]
    v_lshlrev_b32 v52, 16, v120
    v_and_b32 v53, 0xffff0000, v120
    v_pk_fma_f32 v[52:53], v[52:53], v[44:45], v[44:45] op_sel:[0,0,1] op_sel_hi:[1,0,1]
    v_cvt_pk_bf16_f32 v120, v52, v53
    v_lshlrev_b32 v54, 16, v121
    v_and_b32 v55, 0xffff0000, v121
    v_pk_fma_f32 v[54:55], v[54:55], v[44:45], v[44:45] op_sel:[0,0,1] op_sel_hi:[1,0,1]
    v_cvt_pk_bf16_f32 v121, v54, v55
    v_lshlrev_b32 v52, 16, v122
    v_and_b32 v53, 0xffff0000, v122
    v_pk_fma_f32 v[52:53], v[52:53], v[44:45], v[44:45] op_sel:[0,0,1] op_sel_hi:[1,0,1]
    v_cvt_pk_bf16_f32 v122, v52, v53
    v_lshlrev_b32 v54, 16, v123
    v_and_b32 v55, 0xffff0000, v123
    v_pk_fma_f32 v[54:55], v[54:55], v[44:45], v[44:45] op_sel:[0,0,1] op_sel_hi:[1,0,1]
    v_cvt_pk_bf16_f32 v123, v54, v55
    v_lshlrev_b32 v52, 16, v124
    v_and_b32 v53, 0xffff0000, v124
    v_pk_fma_f32 v[52:53], v[52:53], v[44:45], v[44:45] op_sel:[0,0,1] op_sel_hi:[1,0,1]
    v_cvt_pk_bf16_f32 v124, v52, v53
    v_lshlrev_b32 v54, 16, v125
    v_and_b32 v55, 0xffff0000, v125
    v_pk_fma_f32 v[54:55], v[54:55], v[44:45], v[44:45] op_sel:[0,0,1] op_sel_hi:[1,0,1]
    v_cvt_pk_bf16_f32 v125, v54, v55
    v_lshlrev_b32 v52, 16, v126
    v_and_b32 v53, 0xffff0000, v126
    v_pk_fma_f32 v[52:53], v[52:53], v[44:45], v[44:45] op_sel:[0,0,1] op_sel_hi:[1,0,1]
    v_cvt_pk_bf16_f32 v126, v52, v53
    v_lshlrev_b32 v54, 16, v127
    v_and_b32 v55, 0xffff0000, v127
    v_pk_fma_f32 v[54:55], v[54:55], v[44:45], v[44:45] op_sel:[0,0,1] op_sel_hi:[1,0,1]
    v_cvt_pk_bf16_f32 v127, v54, v55
    s_waitcnt vmcnt(6)
    ds_read_b128 v[208:211], v3 offset:8192
    ds_read_b128 v[212:215], v4 offset:8192
    s_add_u32 m0, s92, 98304
    s_add_u32 s5, s32, s74
    s_add_u32 s5, s5, 5120
    buffer_load_dwordx4 v13, s[36:39], s5 offen offset:0  lds
    buffer_load_dwordx4 v14, s[36:39], s5 offen offset:1024  lds
    s_waitcnt lgkmcnt(2)
    v_mfma_f32_16x16x32_bf16 a[220:223], a[216:219], v[200:203], a[220:223]
    v_mfma_f32_16x16x32_bf16 a[224:227], v[200:203], v[200:203], a[224:227]
    v_mfma_f32_16x16x32_bf16 a[220:223], a[216:219], v[204:207], a[220:223]
    v_mfma_f32_16x16x32_bf16 a[224:227], v[204:207], v[204:207], a[224:227]
    v_lshlrev_b32 v52, 16, v128
    v_and_b32 v53, 0xffff0000, v128
    v_pk_fma_f32 v[52:53], v[52:53], v[44:45], v[44:45] op_sel:[0,0,1] op_sel_hi:[1,0,1]
    v_cvt_pk_bf16_f32 v128, v52, v53
    v_lshlrev_b32 v54, 16, v129
    v_and_b32 v55, 0xffff0000, v129
    v_pk_fma_f32 v[54:55], v[54:55], v[44:45], v[44:45] op_sel:[0,0,1] op_sel_hi:[1,0,1]
    v_cvt_pk_bf16_f32 v129, v54, v55
    v_lshlrev_b32 v52, 16, v130
    v_and_b32 v53, 0xffff0000, v130
    v_pk_fma_f32 v[52:53], v[52:53], v[44:45], v[44:45] op_sel:[0,0,1] op_sel_hi:[1,0,1]
    v_cvt_pk_bf16_f32 v130, v52, v53
    v_lshlrev_b32 v54, 16, v131
    v_and_b32 v55, 0xffff0000, v131
    v_pk_fma_f32 v[54:55], v[54:55], v[44:45], v[44:45] op_sel:[0,0,1] op_sel_hi:[1,0,1]
    v_cvt_pk_bf16_f32 v131, v54, v55
    v_lshlrev_b32 v52, 16, v132
    v_and_b32 v53, 0xffff0000, v132
    v_pk_fma_f32 v[52:53], v[52:53], v[44:45], v[44:45] op_sel:[0,0,1] op_sel_hi:[1,0,1]
    v_cvt_pk_bf16_f32 v132, v52, v53
    v_lshlrev_b32 v54, 16, v133
    v_and_b32 v55, 0xffff0000, v133
    v_pk_fma_f32 v[54:55], v[54:55], v[44:45], v[44:45] op_sel:[0,0,1] op_sel_hi:[1,0,1]
    v_cvt_pk_bf16_f32 v133, v54, v55
    v_lshlrev_b32 v52, 16, v134
    v_and_b32 v53, 0xffff0000, v134
    v_pk_fma_f32 v[52:53], v[52:53], v[44:45], v[44:45] op_sel:[0,0,1] op_sel_hi:[1,0,1]
    v_cvt_pk_bf16_f32 v134, v52, v53
    v_lshlrev_b32 v54, 16, v135
    v_and_b32 v55, 0xffff0000, v135
    v_pk_fma_f32 v[54:55], v[54:55], v[44:45], v[44:45] op_sel:[0,0,1] op_sel_hi:[1,0,1]
    v_cvt_pk_bf16_f32 v135, v54, v55
    s_waitcnt vmcnt(6)
    ds_read_b128 v[216:219], v3 offset:10240
    ds_read_b128 v[220:223], v4 offset:10240
    buffer_load_dwordx4 v15, s[36:39], s5 offen offset:2048  lds
    buffer_load_dwordx4 v16, s[36:39], s5 offen offset:3072  lds
    s_waitcnt lgkmcnt(2)
    v_mfma_f32_16x16x32_bf16 a[220:223], a[216:219], v[208:211], a[220:223]
    v_mfma_f32_16x16x32_bf16 a[224:227], v[208:211], v[208:211], a[224:227]
    v_mfma_f32_16x16x32_bf16 a[220:223], a[216:219], v[212:215], a[220:223]
    v_mfma_f32_16x16x32_bf16 a[224:227], v[212:215], v[212:215], a[224:227]
    v_lshlrev_b32 v52, 16, v136
    v_and_b32 v53, 0xffff0000, v136
    v_pk_fma_f32 v[52:53], v[52:53], v[44:45], v[44:45] op_sel:[0,0,1] op_sel_hi:[1,0,1]
    v_cvt_pk_bf16_f32 v136, v52, v53
    v_lshlrev_b32 v54, 16, v137
    v_and_b32 v55, 0xffff0000, v137
    v_pk_fma_f32 v[54:55], v[54:55], v[44:45], v[44:45] op_sel:[0,0,1] op_sel_hi:[1,0,1]
    v_cvt_pk_bf16_f32 v137, v54, v55
    v_lshlrev_b32 v52, 16, v138
    v_and_b32 v53, 0xffff0000, v138
    v_pk_fma_f32 v[52:53], v[52:53], v[44:45], v[44:45] op_sel:[0,0,1] op_sel_hi:[1,0,1]
    v_cvt_pk_bf16_f32 v138, v52, v53
    v_lshlrev_b32 v54, 16, v139
    v_and_b32 v55, 0xffff0000, v139
    v_pk_fma_f32 v[54:55], v[54:55], v[44:45], v[44:45] op_sel:[0,0,1] op_sel_hi:[1,0,1]
    v_cvt_pk_bf16_f32 v139, v54, v55
    v_lshlrev_b32 v52, 16, v140
    v_and_b32 v53, 0xffff0000, v140
    v_pk_fma_f32 v[52:53], v[52:53], v[44:45], v[44:45] op_sel:[0,0,1] op_sel_hi:[1,0,1]
    v_cvt_pk_bf16_f32 v140, v52, v53
    v_lshlrev_b32 v54, 16, v141
    v_and_b32 v55, 0xffff0000, v141
    v_pk_fma_f32 v[54:55], v[54:55], v[44:45], v[44:45] op_sel:[0,0,1] op_sel_hi:[1,0,1]
    v_cvt_pk_bf16_f32 v141, v54, v55
    v_lshlrev_b32 v52, 16, v142
    v_and_b32 v53, 0xffff0000, v142
    v_pk_fma_f32 v[52:53], v[52:53], v[44:45], v[44:45] op_sel:[0,0,1] op_sel_hi:[1,0,1]
    v_cvt_pk_bf16_f32 v142, v52, v53
    v_lshlrev_b32 v54, 16, v143
    v_and_b32 v55, 0xffff0000, v143
    v_pk_fma_f32 v[54:55], v[54:55], v[44:45], v[44:45] op_sel:[0,0,1] op_sel_hi:[1,0,1]
    v_cvt_pk_bf16_f32 v143, v54, v55
    s_waitcnt vmcnt(6)
    ds_read_b128 v[224:227], v3 offset:12288
    ds_read_b128 v[228:231], v4 offset:12288
    s_add_u32 m0, s18, 0
    s_add_u32 s5, s22, s75
    buffer_load_dwordx4 v11, s[40:43], s5 offen offset:0  lds
    buffer_load_dwordx4 v27, s[40:43], s5 offen offset:1024  lds
    s_waitcnt lgkmcnt(2)
    v_mfma_f32_16x16x32_bf16 a[220:223], a[216:219], v[216:219], a[220:223]
    v_mfma_f32_16x16x32_bf16 a[224:227], v[216:219], v[216:219], a[224:227]
    v_mfma_f32_16x16x32_bf16 a[220:223], a[216:219], v[220:223], a[220:223]
    v_mfma_f32_16x16x32_bf16 a[224:227], v[220:223], v[220:223], a[224:227]
    v_lshlrev_b32 v52, 16, v144
    v_and_b32 v53, 0xffff0000, v144
    v_pk_fma_f32 v[52:53], v[52:53], v[44:45], v[44:45] op_sel:[0,0,1] op_sel_hi:[1,0,1]
    v_cvt_pk_bf16_f32 v144, v52, v53
    v_lshlrev_b32 v54, 16, v145
    v_and_b32 v55, 0xffff0000, v145
    v_pk_fma_f32 v[54:55], v[54:55], v[44:45], v[44:45] op_sel:[0,0,1] op_sel_hi:[1,0,1]
    v_cvt_pk_bf16_f32 v145, v54, v55
    v_lshlrev_b32 v52, 16, v146
    v_and_b32 v53, 0xffff0000, v146
    v_pk_fma_f32 v[52:53], v[52:53], v[44:45], v[44:45] op_sel:[0,0,1] op_sel_hi:[1,0,1]
    v_cvt_pk_bf16_f32 v146, v52, v53
    v_lshlrev_b32 v54, 16, v147
    v_and_b32 v55, 0xffff0000, v147
    v_pk_fma_f32 v[54:55], v[54:55], v[44:45], v[44:45] op_sel:[0,0,1] op_sel_hi:[1,0,1]
    v_cvt_pk_bf16_f32 v147, v54, v55
    v_lshlrev_b32 v52, 16, v148
    v_and_b32 v53, 0xffff0000, v148
    v_pk_fma_f32 v[52:53], v[52:53], v[44:45], v[44:45] op_sel:[0,0,1] op_sel_hi:[1,0,1]
    v_cvt_pk_bf16_f32 v148, v52, v53
    v_lshlrev_b32 v54, 16, v149
    v_and_b32 v55, 0xffff0000, v149
    v_pk_fma_f32 v[54:55], v[54:55], v[44:45], v[44:45] op_sel:[0,0,1] op_sel_hi:[1,0,1]
    v_cvt_pk_bf16_f32 v149, v54, v55
    v_lshlrev_b32 v52, 16, v150
    v_and_b32 v53, 0xffff0000, v150
    v_pk_fma_f32 v[52:53], v[52:53], v[44:45], v[44:45] op_sel:[0,0,1] op_sel_hi:[1,0,1]
    v_cvt_pk_bf16_f32 v150, v52, v53
    v_lshlrev_b32 v54, 16, v151
    v_and_b32 v55, 0xffff0000, v151
    v_pk_fma_f32 v[54:55], v[54:55], v[44:45], v[44:45] op_sel:[0,0,1] op_sel_hi:[1,0,1]
    v_cvt_pk_bf16_f32 v151, v54, v55
    s_waitcnt vmcnt(6)
    ds_read_b128 v[232:235], v3 offset:14336
    ds_read_b128 v[236:239], v4 offset:14336
    buffer_load_dwordx4 v28, s[40:43], s5 offen offset:2048  lds
    buffer_load_dwordx4 v29, s[40:43], s5 offen offset:3072  lds
    s_waitcnt lgkmcnt(2)
    v_mfma_f32_16x16x32_bf16 a[220:223], a[216:219], v[224:227], a[220:223]
    v_mfma_f32_16x16x32_bf16 a[224:227], v[224:227], v[224:227], a[224:227]
    v_mfma_f32_16x16x32_bf16 a[220:223], a[216:219], v[228:231], a[220:223]
    v_mfma_f32_16x16x32_bf16 a[224:227], v[228:231], v[228:231], a[224:227]
    v_lshlrev_b32 v52, 16, v152
    v_and_b32 v53, 0xffff0000, v152
    v_pk_fma_f32 v[52:53], v[52:53], v[44:45], v[44:45] op_sel:[0,0,1] op_sel_hi:[1,0,1]
    v_cvt_pk_bf16_f32 v152, v52, v53
    v_lshlrev_b32 v54, 16, v153
    v_and_b32 v55, 0xffff0000, v153
    v_pk_fma_f32 v[54:55], v[54:55], v[44:45], v[44:45] op_sel:[0,0,1] op_sel_hi:[1,0,1]
    v_cvt_pk_bf16_f32 v153, v54, v55
    v_lshlrev_b32 v52, 16, v154
    v_and_b32 v53, 0xffff0000, v154
    v_pk_fma_f32 v[52:53], v[52:53], v[44:45], v[44:45] op_sel:[0,0,1] op_sel_hi:[1,0,1]
    v_cvt_pk_bf16_f32 v154, v52, v53
    v_lshlrev_b32 v54, 16, v155
    v_and_b32 v55, 0xffff0000, v155
    v_pk_fma_f32 v[54:55], v[54:55], v[44:45], v[44:45] op_sel:[0,0,1] op_sel_hi:[1,0,1]
    v_cvt_pk_bf16_f32 v155, v54, v55
    v_lshlrev_b32 v52, 16, v156
    v_and_b32 v53, 0xffff0000, v156
    v_pk_fma_f32 v[52:53], v[52:53], v[44:45], v[44:45] op_sel:[0,0,1] op_sel_hi:[1,0,1]
    v_cvt_pk_bf16_f32 v156, v52, v53
    v_lshlrev_b32 v54, 16, v157
    v_and_b32 v55, 0xffff0000, v157
    v_pk_fma_f32 v[54:55], v[54:55], v[44:45], v[44:45] op_sel:[0,0,1] op_sel_hi:[1,0,1]
    v_cvt_pk_bf16_f32 v157, v54, v55
    v_lshlrev_b32 v52, 16, v158
    v_and_b32 v53, 0xffff0000, v158
    v_pk_fma_f32 v[52:53], v[52:53], v[44:45], v[44:45] op_sel:[0,0,1] op_sel_hi:[1,0,1]
    v_cvt_pk_bf16_f32 v158, v52, v53
    v_lshlrev_b32 v54, 16, v159
    v_and_b32 v55, 0xffff0000, v159
    v_pk_fma_f32 v[54:55], v[54:55], v[44:45], v[44:45] op_sel:[0,0,1] op_sel_hi:[1,0,1]
    v_cvt_pk_bf16_f32 v159, v54, v55
    s_waitcnt vmcnt(6)
    ds_read_b128 v[240:243], v3 offset:16384
    ds_read_b128 v[244:247], v4 offset:16384
    s_add_u32 m0, s18, 4096
    s_add_u32 s5, s5, 40960
    buffer_load_dwordx4 v11, s[40:43], s5 offen offset:0  lds
    s_add_u32 m0, s18, 20480
    s_add_u32 s5, s23, s75
    buffer_load_dwordx4 v11, s[40:43], s5 offen offset:0  lds
    s_waitcnt lgkmcnt(2)
    v_mfma_f32_16x16x32_bf16 a[220:223], a[216:219], v[232:235], a[220:223]
    v_mfma_f32_16x16x32_bf16 a[224:227], v[232:235], v[232:235], a[224:227]
    v_mfma_f32_16x16x32_bf16 a[220:223], a[216:219], v[236:239], a[220:223]
    v_mfma_f32_16x16x32_bf16 a[224:227], v[236:239], v[236:239], a[224:227]
    v_lshlrev_b32 v52, 16, v160
    v_and_b32 v53, 0xffff0000, v160
    v_pk_fma_f32 v[52:53], v[52:53], v[44:45], v[44:45] op_sel:[0,0,1] op_sel_hi:[1,0,1]
    v_cvt_pk_bf16_f32 v160, v52, v53
    v_lshlrev_b32 v54, 16, v161
    v_and_b32 v55, 0xffff0000, v161
    v_pk_fma_f32 v[54:55], v[54:55], v[44:45], v[44:45] op_sel:[0,0,1] op_sel_hi:[1,0,1]
    v_cvt_pk_bf16_f32 v161, v54, v55
    v_lshlrev_b32 v52, 16, v162
    v_and_b32 v53, 0xffff0000, v162
    v_pk_fma_f32 v[52:53], v[52:53], v[44:45], v[44:45] op_sel:[0,0,1] op_sel_hi:[1,0,1]
    v_cvt_pk_bf16_f32 v162, v52, v53
    v_lshlrev_b32 v54, 16, v163
    v_and_b32 v55, 0xffff0000, v163
    v_pk_fma_f32 v[54:55], v[54:55], v[44:45], v[44:45] op_sel:[0,0,1] op_sel_hi:[1,0,1]
    v_cvt_pk_bf16_f32 v163, v54, v55
    v_lshlrev_b32 v52, 16, v164
    v_and_b32 v53, 0xffff0000, v164
    v_pk_fma_f32 v[52:53], v[52:53], v[44:45], v[44:45] op_sel:[0,0,1] op_sel_hi:[1,0,1]
    v_cvt_pk_bf16_f32 v164, v52, v53
    v_lshlrev_b32 v54, 16, v165
    v_and_b32 v55, 0xffff0000, v165
    v_pk_fma_f32 v[54:55], v[54:55], v[44:45], v[44:45] op_sel:[0,0,1] op_sel_hi:[1,0,1]
    v_cvt_pk_bf16_f32 v165, v54, v55
    v_lshlrev_b32 v52, 16, v166
    v_and_b32 v53, 0xffff0000, v166
    v_pk_fma_f32 v[52:53], v[52:53], v[44:45], v[44:45] op_sel:[0,0,1] op_sel_hi:[1,0,1]
    v_cvt_pk_bf16_f32 v166, v52, v53
    v_lshlrev_b32 v54, 16, v167
    v_and_b32 v55, 0xffff0000, v167
    v_pk_fma_f32 v[54:55], v[54:55], v[44:45], v[44:45] op_sel:[0,0,1] op_sel_hi:[1,0,1]
    v_cvt_pk_bf16_f32 v167, v54, v55
    s_waitcnt vmcnt(6)
    ds_read_b128 v[248:251], v3 offset:18432
    ds_read_b128 v[252:255], v4 offset:18432
    buffer_load_dwordx4 v27, s[40:43], s5 offen offset:1024  lds
    buffer_load_dwordx4 v28, s[40:43], s5 offen offset:2048  lds
    s_waitcnt lgkmcnt(2)
    v_mfma_f32_16x16x32_bf16 a[220:223], a[216:219], v[240:243], a[220:223]
    v_mfma_f32_16x16x32_bf16 a[224:227], v[240:243], v[240:243], a[224:227]
    v_mfma_f32_16x16x32_bf16 a[220:223], a[216:219], v[244:247], a[220:223]
    v_mfma_f32_16x16x32_bf16 a[224:227], v[244:247], v[244:247], a[224:227]
    v_lshlrev_b32 v52, 16, v168
    v_and_b32 v53, 0xffff0000, v168
    v_pk_fma_f32 v[52:53], v[52:53], v[44:45], v[44:45] op_sel:[0,0,1] op_sel_hi:[1,0,1]
    v_cvt_pk_bf16_f32 v168, v52, v53
    v_lshlrev_b32 v54, 16, v169
    v_and_b32 v55, 0xffff0000, v169
    v_pk_fma_f32 v[54:55], v[54:55], v[44:45], v[44:45] op_sel:[0,0,1] op_sel_hi:[1,0,1]
    v_cvt_pk_bf16_f32 v169, v54, v55
    v_lshlrev_b32 v52, 16, v170
    v_and_b32 v53, 0xffff0000, v170
    v_pk_fma_f32 v[52:53], v[52:53], v[44:45], v[44:45] op_sel:[0,0,1] op_sel_hi:[1,0,1]
    v_cvt_pk_bf16_f32 v170, v52, v53
    v_lshlrev_b32 v54, 16, v171
    v_and_b32 v55, 0xffff0000, v171
    v_pk_fma_f32 v[54:55], v[54:55], v[44:45], v[44:45] op_sel:[0,0,1] op_sel_hi:[1,0,1]
    v_cvt_pk_bf16_f32 v171, v54, v55
    v_lshlrev_b32 v52, 16, v172
    v_and_b32 v53, 0xffff0000, v172
    v_pk_fma_f32 v[52:53], v[52:53], v[44:45], v[44:45] op_sel:[0,0,1] op_sel_hi:[1,0,1]
    v_cvt_pk_bf16_f32 v172, v52, v53
    v_lshlrev_b32 v54, 16, v173
    v_and_b32 v55, 0xffff0000, v173
    v_pk_fma_f32 v[54:55], v[54:55], v[44:45], v[44:45] op_sel:[0,0,1] op_sel_hi:[1,0,1]
    v_cvt_pk_bf16_f32 v173, v54, v55
    v_lshlrev_b32 v52, 16, v174
    v_and_b32 v53, 0xffff0000, v174
    v_pk_fma_f32 v[52:53], v[52:53], v[44:45], v[44:45] op_sel:[0,0,1] op_sel_hi:[1,0,1]
    v_cvt_pk_bf16_f32 v174, v52, v53
    v_lshlrev_b32 v54, 16, v175
    v_and_b32 v55, 0xffff0000, v175
    v_pk_fma_f32 v[54:55], v[54:55], v[44:45], v[44:45] op_sel:[0,0,1] op_sel_hi:[1,0,1]
    v_cvt_pk_bf16_f32 v175, v54, v55
    s_waitcnt lgkmcnt(0)
    v_mfma_f32_16x16x32_bf16 a[220:223], a[216:219], v[248:251], a[220:223]
    buffer_load_dwordx4 v29, s[40:43], s5 offen offset:3072  lds
    v_mfma_f32_16x16x32_bf16 a[224:227], v[248:251], v[248:251], a[224:227]
    s_add_u32 m0, s18, 24576
    s_add_u32 s5, s5, 40960
    buffer_load_dwordx4 v11, s[40:43], s5 offen offset:0  lds
    v_mfma_f32_16x16x32_bf16 a[220:223], a[216:219], v[252:255], a[220:223]
    v_mfma_f32_16x16x32_bf16 a[224:227], v[252:255], v[252:255], a[224:227]
    v_and_b32 v51, 15, v1
    v_lshrrev_b32 v52, 2, v51
    v_lshl_add_u32 v52, v52, 4, v51
    v_lshlrev_b32 v52, 2, v52
    v_and_b32 v51, 3, v1
    v_cmp_eq_u32 s[88:89], 1, v51
    v_cmp_eq_u32 s[90:91], 2, v51
    v_cmp_eq_u32 vcc, 3, v51
    v_accvgpr_read_b32 v40, a224
    v_accvgpr_read_b32 v41, a225
    v_accvgpr_read_b32 v42, a226
    v_accvgpr_read_b32 v43, a227
    v_cndmask_b32 v40, v40, v41, s[88:89]
    v_cndmask_b32 v42, v42, v43, vcc
    v_cndmask_b32 v40, v40, v42, s[90:91]
    v_cndmask_b32 v40, v40, v42, vcc
    ds_bpermute_b32 v42, v52, v40
    v_accvgpr_read_b32 v40, a220
    v_mul_f32 v40, 0x3acccccd, v40
    s_waitcnt lgkmcnt(0)
    v_mul_f32 v42, 0x3acccccd, v42
    v_fma_f32 v42, -v40, v40, v42
    v_max_f32 v42, 0, v42
    v_cvt_pk_bf16_f32 v51, v40, v42
    v_lshlrev_b32 v49, 16, v51
    v_and_b32 v52, 0xffff0000, v51
    v_add_f32 v52, 0x3727c5ac, v52
    v_cvt_pk_bf16_f32 v52, v52, v52
    v_and_b32 v52, 0xffff0000, v52
    v_sqrt_f32 v52, v52
    s_nop 0
    v_cvt_pk_bf16_f32 v52, v52, v52
    v_and_b32 v52, 0xffff0000, v52
    v_rcp_f32 v46, v52
    s_nop 0
    v_mul_f32 v47, v49, v46
    v_sub_f32 v47, 0, v47
    v_lshrrev_b32 v14, 3, v1
    v_and_b32 v15, 7, v1
    v_and_b32 v16, 2, v14
    v_lshlrev_b32 v16, 1, v16
    v_xor_b32 v15, v15, v16
    v_lshlrev_b32 v15, 4, v15
    v_mul_u32_u24 v14, 3072, v14
    v_add_u32 v13, v14, v15
    v_add_u32 v14, 23552, v13
    v_add_u32 v15, 47104, v13
    v_add_u32 v16, 70656, v13
    v_lshlrev_b32 v52, 16, v176
    v_and_b32 v53, 0xffff0000, v176
    v_pk_fma_f32 v[52:53], v[52:53], v[46:47], v[46:47] op_sel:[0,0,1] op_sel_hi:[1,0,1]
    v_cvt_pk_bf16_f32 v176, v52, v53
    v_lshlrev_b32 v54, 16, v177
    v_and_b32 v55, 0xffff0000, v177
    v_pk_fma_f32 v[54:55], v[54:55], v[46:47], v[46:47] op_sel:[0,0,1] op_sel_hi:[1,0,1]
    v_cvt_pk_bf16_f32 v177, v54, v55
    v_lshlrev_b32 v52, 16, v178
    v_and_b32 v53, 0xffff0000, v178
    v_pk_fma_f32 v[52:53], v[52:53], v[46:47], v[46:47] op_sel:[0,0,1] op_sel_hi:[1,0,1]
    v_cvt_pk_bf16_f32 v178, v52, v53
    v_lshlrev_b32 v54, 16, v179
    v_and_b32 v55, 0xffff0000, v179
    v_pk_fma_f32 v[54:55], v[54:55], v[46:47], v[46:47] op_sel:[0,0,1] op_sel_hi:[1,0,1]
    v_cvt_pk_bf16_f32 v179, v54, v55
    s_waitcnt vmcnt(5)
    s_barrier
    ds_read_b128 a[64:67], v5 offset:0
    ds_read_b128 a[68:71], v5 offset:1024
    ds_read_b128 a[72:75], v5 offset:2048
    ds_read_b128 a[76:79], v5 offset:3072
    ds_read_b128 a[80:83], v5 offset:4096
    s_waitcnt lgkmcnt(4)
    v_mfma_f32_16x16x32_bf16 v[56:59], v[96:99], a[64:67], 0
    ds_read_b128 a[96:99], v6 offset:0
    v_lshlrev_b32 v52, 16, v180
    v_and_b32 v53, 0xffff0000, v180
    v_mfma_f32_16x16x32_bf16 v[60:63], v[176:179], a[64:67], 0
    ds_read_b128 a[100:103], v6 offset:1024
    v_fma_f32 v52, v52, v46, v47
    v_fma_f32 v53, v53, v46, v47
    s_add_u32 m0, s18, 40960
    s_add_u32 s5, s0, s75
    buffer_load_dwordx4 v11, s[40:43], s5 offen offset:0  lds
    s_waitcnt lgkmcnt(5)
    v_mfma_f32_16x16x32_bf16 v[64:67], v[96:99], a[68:71], 0
    ds_read_b128 a[104:107], v6 offset:2048
    v_cvt_pk_bf16_f32 v180, v52, v53
    v_lshlrev_b32 v54, 16, v181
    buffer_load_dwordx4 v27, s[40:43], s5 offen offset:1024  lds
    v_mfma_f32_16x16x32_bf16 v[68:71], v[176:179], a[68:71], 0
    ds_read_b128 a[108:111], v6 offset:3072
    v_and_b32 v55, 0xffff0000, v181
    v_fma_f32 v54, v54, v46, v47
    s_waitcnt lgkmcnt(6)
    v_mfma_f32_16x16x32_bf16 v[72:75], v[96:99], a[72:75], 0
    ds_read_b128 a[112:115], v6 offset:4096
    v_fma_f32 v55, v55, v46, v47
    v_cvt_pk_bf16_f32 v181, v54, v55
    buffer_load_dwordx4 v28, s[40:43], s5 offen offset:2048  lds
    v_mfma_f32_16x16x32_bf16 v[76:79], v[176:179], a[72:75], 0
    v_lshlrev_b32 v52, 16, v182
    v_and_b32 v53, 0xffff0000, v182
    s_waitcnt lgkmcnt(6)
    v_mfma_f32_16x16x32_bf16 v[80:83], v[96:99], a[76:79], 0
    v_fma_f32 v52, v52, v46, v47
    v_fma_f32 v53, v53, v46, v47
    v_mfma_f32_16x16x32_bf16 v[84:87], v[176:179], a[76:79], 0
    v_cvt_pk_bf16_f32 v182, v52, v53
    v_lshlrev_b32 v54, 16, v183
    s_waitcnt lgkmcnt(5)
    v_mfma_f32_16x16x32_bf16 v[88:91], v[96:99], a[80:83], 0
    v_and_b32 v55, 0xffff0000, v183
    v_fma_f32 v54, v54, v46, v47
    buffer_load_dwordx4 v29, s[40:43], s5 offen offset:3072  lds
    v_mfma_f32_16x16x32_bf16 v[92:95], v[176:179], a[80:83], 0
    v_fma_f32 v55, v55, v46, v47
    v_cvt_pk_bf16_f32 v183, v54, v55
    s_waitcnt lgkmcnt(0)
    v_mfma_f32_16x16x32_bf16 v[56:59], v[100:103], a[96:99], v[56:59]
    ds_read_b128 a[64:67], v5 offset:10240
    v_lshlrev_b32 v52, 16, v184
    v_and_b32 v53, 0xffff0000, v184
    v_mfma_f32_16x16x32_bf16 v[60:63], v[180:183], a[96:99], v[60:63]
    ds_read_b128 a[68:71], v5 offset:11264
    v_fma_f32 v52, v52, v46, v47
    v_fma_f32 v53, v53, v46, v47
    s_add_u32 m0, s18, 45056
    s_add_u32 s5, s5, 40960
    buffer_load_dwordx4 v11, s[40:43], s5 offen offset:0  lds
    v_mfma_f32_16x16x32_bf16 v[64:67], v[100:103], a[100:103], v[64:67]
    ds_read_b128 a[72:75], v5 offset:12288
    v_cvt_pk_bf16_f32 v184, v52, v53
    v_lshlrev_b32 v54, 16, v185
    v_mfma_f32_16x16x32_bf16 v[68:71], v[180:183], a[100:103], v[68:71]
    ds_read_b128 a[76:79], v5 offset:13312
    v_and_b32 v55, 0xffff0000, v185
    v_fma_f32 v54, v54, v46, v47
    v_mfma_f32_16x16x32_bf16 v[72:75], v[100:103], a[104:107], v[72:75]
    ds_read_b128 a[80:83], v5 offset:14336
    v_fma_f32 v55, v55, v46, v47
    v_cvt_pk_bf16_f32 v185, v54, v55
    s_cmp_lt_u32 s19, 1073741824
    s_cselect_b32 s98, 0, 1073741824
    buffer_store_dwordx2 v[30:31], off, s[60:63], s98 sc1
    v_mfma_f32_16x16x32_bf16 v[76:79], v[180:183], a[104:107], v[76:79]
    v_lshlrev_b32 v52, 16, v186
    v_and_b32 v53, 0xffff0000, v186
    s_add_u32 m0, s18, 61440
    s_add_u32 s5, s1, s75
    buffer_load_dwordx4 v11, s[40:43], s5 offen offset:0  lds
    v_mfma_f32_16x16x32_bf16 v[80:83], v[100:103], a[108:111], v[80:83]
    v_fma_f32 v52, v52, v46, v47
    v_fma_f32 v53, v53, v46, v47
    v_mfma_f32_16x16x32_bf16 v[84:87], v[180:183], a[108:111], v[84:87]
    v_cvt_pk_bf16_f32 v186, v52, v53
    v_lshlrev_b32 v54, 16, v187
    v_mfma_f32_16x16x32_bf16 v[88:91], v[100:103], a[112:115], v[88:91]
    v_and_b32 v55, 0xffff0000, v187
    v_fma_f32 v54, v54, v46, v47
    buffer_load_dwordx4 v27, s[40:43], s5 offen offset:1024  lds
    v_mfma_f32_16x16x32_bf16 v[92:95], v[180:183], a[112:115], v[92:95]
    v_fma_f32 v55, v55, v46, v47
    v_cvt_pk_bf16_f32 v187, v54, v55
    s_waitcnt lgkmcnt(0)
    v_mfma_f32_16x16x32_bf16 v[56:59], v[104:107], a[64:67], v[56:59]
    ds_read_b128 a[96:99], v6 offset:10240
    v_lshlrev_b32 v52, 16, v188
    v_and_b32 v53, 0xffff0000, v188
    v_mfma_f32_16x16x32_bf16 v[60:63], v[184:187], a[64:67], v[60:63]
    ds_read_b128 a[100:103], v6 offset:11264
    v_fma_f32 v52, v52, v46, v47
    v_fma_f32 v53, v53, v46, v47
    v_mfma_f32_16x16x32_bf16 v[64:67], v[104:107], a[68:71], v[64:67]
    ds_read_b128 a[104:107], v6 offset:12288
    v_cvt_pk_bf16_f32 v188, v52, v53
    v_lshlrev_b32 v54, 16, v189
    buffer_load_dwordx4 v28, s[40:43], s5 offen offset:2048  lds
    v_mfma_f32_16x16x32_bf16 v[68:71], v[184:187], a[68:71], v[68:71]
    ds_read_b128 a[108:111], v6 offset:13312
    v_and_b32 v55, 0xffff0000, v189
    v_fma_f32 v54, v54, v46, v47
    buffer_load_dwordx4 v29, s[40:43], s5 offen offset:3072  lds
    v_mfma_f32_16x16x32_bf16 v[72:75], v[104:107], a[72:75], v[72:75]
    ds_read_b128 a[112:115], v6 offset:14336
    v_fma_f32 v55, v55, v46, v47
    v_cvt_pk_bf16_f32 v189, v54, v55
    s_add_u32 m0, s18, 65536
    s_add_u32 s5, s5, 40960
    buffer_load_dwordx4 v11, s[40:43], s5 offen offset:0  lds
    v_mfma_f32_16x16x32_bf16 v[76:79], v[184:187], a[72:75], v[76:79]
    v_lshlrev_b32 v52, 16, v190
    v_and_b32 v53, 0xffff0000, v190
    s_add_u32 m0, s18, 81920
    s_add_u32 s5, s32, s75
    buffer_load_dwordx4 v11, s[40:43], s5 offen offset:0  lds
    v_mfma_f32_16x16x32_bf16 v[80:83], v[104:107], a[76:79], v[80:83]
    v_fma_f32 v52, v52, v46, v47
    v_fma_f32 v53, v53, v46, v47
    buffer_load_dwordx4 v27, s[40:43], s5 offen offset:1024  lds
    v_mfma_f32_16x16x32_bf16 v[84:87], v[184:187], a[76:79], v[84:87]
    v_cvt_pk_bf16_f32 v190, v52, v53
    v_lshlrev_b32 v54, 16, v191
    buffer_load_dwordx4 v28, s[40:43], s5 offen offset:2048  lds
    v_mfma_f32_16x16x32_bf16 v[88:91], v[104:107], a[80:83], v[88:91]
    v_and_b32 v55, 0xffff0000, v191
    v_fma_f32 v54, v54, v46, v47
    v_mfma_f32_16x16x32_bf16 v[92:95], v[184:187], a[80:83], v[92:95]
    v_fma_f32 v55, v55, v46, v47
    v_cvt_pk_bf16_f32 v191, v54, v55
    s_waitcnt lgkmcnt(0)
    v_mfma_f32_16x16x32_bf16 v[56:59], v[108:111], a[96:99], v[56:59]
    s_waitcnt vmcnt(14)
    s_barrier
    v_lshlrev_b32 v52, 16, v192
    v_and_b32 v53, 0xffff0000, v192
    v_mfma_f32_16x16x32_bf16 v[60:63], v[188:191], a[96:99], v[60:63]
    ds_read_b128 a[64:67], v5 offset:20480
    v_fma_f32 v52, v52, v46, v47
    v_fma_f32 v53, v53, v46, v47
    buffer_load_dwordx4 v29, s[40:43], s5 offen offset:3072  lds
    v_mfma_f32_16x16x32_bf16 v[64:67], v[108:111], a[100:103], v[64:67]
    ds_read_b128 a[68:71], v5 offset:21504
    v_cvt_pk_bf16_f32 v192, v52, v53
    v_lshlrev_b32 v54, 16, v193
    s_add_u32 m0, s18, 86016
    s_add_u32 s5, s5, 40960
    buffer_load_dwordx4 v11, s[40:43], s5 offen offset:0  lds
    v_mfma_f32_16x16x32_bf16 v[68:71], v[188:191], a[100:103], v[68:71]
    ds_read_b128 a[72:75], v5 offset:22528
    v_and_b32 v55, 0xffff0000, v193
    v_fma_f32 v54, v54, v46, v47
    v_mfma_f32_16x16x32_bf16 v[72:75], v[108:111], a[104:107], v[72:75]
    ds_read_b128 a[76:79], v5 offset:23552
    v_fma_f32 v55, v55, v46, v47
    v_cvt_pk_bf16_f32 v193, v54, v55
    v_mfma_f32_16x16x32_bf16 v[76:79], v[188:191], a[104:107], v[76:79]
    ds_read_b128 a[80:83], v5 offset:24576
    v_lshlrev_b32 v52, 16, v194
    v_and_b32 v53, 0xffff0000, v194
    s_add_u32 m0, s18, 102400
    v_accvgpr_read_b32 v3, a232
    buffer_load_dwordx4 v3, s[56:59], s78 offen  lds
    v_mfma_f32_16x16x32_bf16 v[80:83], v[108:111], a[108:111], v[80:83]
    v_fma_f32 v52, v52, v46, v47
    v_fma_f32 v53, v53, v46, v47
    v_mfma_f32_16x16x32_bf16 v[84:87], v[188:191], a[108:111], v[84:87]
    v_cvt_pk_bf16_f32 v194, v52, v53
    v_lshlrev_b32 v54, 16, v195
    v_mfma_f32_16x16x32_bf16 v[88:91], v[108:111], a[112:115], v[88:91]
    v_and_b32 v55, 0xffff0000, v195
    v_fma_f32 v54, v54, v46, v47
    v_mfma_f32_16x16x32_bf16 v[92:95], v[188:191], a[112:115], v[92:95]
    v_fma_f32 v55, v55, v46, v47
    v_cvt_pk_bf16_f32 v195, v54, v55
    s_waitcnt lgkmcnt(0)
    v_mfma_f32_16x16x32_bf16 v[56:59], v[112:115], a[64:67], v[56:59]
    ds_read_b128 a[96:99], v6 offset:20480
    v_lshlrev_b32 v52, 16, v196
    v_and_b32 v53, 0xffff0000, v196
    v_mfma_f32_16x16x32_bf16 v[60:63], v[192:195], a[64:67], v[60:63]
    ds_read_b128 a[100:103], v6 offset:21504
    v_fma_f32 v52, v52, v46, v47
    v_fma_f32 v53, v53, v46, v47
    v_mfma_f32_16x16x32_bf16 v[64:67], v[112:115], a[68:71], v[64:67]
    ds_read_b128 a[104:107], v6 offset:22528
    v_cvt_pk_bf16_f32 v196, v52, v53
    v_lshlrev_b32 v54, 16, v197
    v_mfma_f32_16x16x32_bf16 v[68:71], v[192:195], a[68:71], v[68:71]
    ds_read_b128 a[108:111], v6 offset:23552
    v_and_b32 v55, 0xffff0000, v197
    v_fma_f32 v54, v54, v46, v47
    s_add_u32 m0, s18, 103424
    v_accvgpr_read_b32 v3, a233
    buffer_load_dwordx4 v3, s[56:59], s78 offen  lds
    v_mfma_f32_16x16x32_bf16 v[72:75], v[112:115], a[72:75], v[72:75]
    ds_read_b128 a[112:115], v6 offset:24576
    v_fma_f32 v55, v55, v46, v47
    v_cvt_pk_bf16_f32 v197, v54, v55
    v_mfma_f32_16x16x32_bf16 v[76:79], v[192:195], a[72:75], v[76:79]
    v_lshlrev_b32 v52, 16, v198
    v_and_b32 v53, 0xffff0000, v198
    v_mfma_f32_16x16x32_bf16 v[80:83], v[112:115], a[76:79], v[80:83]
    v_fma_f32 v52, v52, v46, v47
    v_fma_f32 v53, v53, v46, v47
    v_mfma_f32_16x16x32_bf16 v[84:87], v[192:195], a[76:79], v[84:87]
    v_cvt_pk_bf16_f32 v198, v52, v53
    v_lshlrev_b32 v54, 16, v199
    v_mfma_f32_16x16x32_bf16 v[88:91], v[112:115], a[80:83], v[88:91]
    v_and_b32 v55, 0xffff0000, v199
    v_fma_f32 v54, v54, v46, v47
    v_mfma_f32_16x16x32_bf16 v[92:95], v[192:195], a[80:83], v[92:95]
    v_fma_f32 v55, v55, v46, v47
    v_cvt_pk_bf16_f32 v199, v54, v55
    s_waitcnt lgkmcnt(0)
    v_mfma_f32_16x16x32_bf16 v[56:59], v[116:119], a[96:99], v[56:59]
    ds_read_b128 a[64:67], v5 offset:30720
    v_lshlrev_b32 v52, 16, v200
    v_and_b32 v53, 0xffff0000, v200
    v_mfma_f32_16x16x32_bf16 v[60:63], v[196:199], a[96:99], v[60:63]
    ds_read_b128 a[68:71], v5 offset:31744
    v_fma_f32 v52, v52, v46, v47
    v_fma_f32 v53, v53, v46, v47
    v_mfma_f32_16x16x32_bf16 v[64:67], v[116:119], a[100:103], v[64:67]
    ds_read_b128 a[72:75], v5 offset:32768
    v_cvt_pk_bf16_f32 v200, v52, v53
    v_lshlrev_b32 v54, 16, v201
    v_mfma_f32_16x16x32_bf16 v[68:71], v[196:199], a[100:103], v[68:71]
    ds_read_b128 a[76:79], v5 offset:33792
    v_and_b32 v55, 0xffff0000, v201
    v_fma_f32 v54, v54, v46, v47
    s_add_u32 m0, s18, 104448
    v_accvgpr_read_b32 v3, a234
    buffer_load_dwordx4 v3, s[56:59], s78 offen  lds
    v_mfma_f32_16x16x32_bf16 v[72:75], v[116:119], a[104:107], v[72:75]
    ds_read_b128 a[80:83], v5 offset:34816
    v_fma_f32 v55, v55, v46, v47
    v_cvt_pk_bf16_f32 v201, v54, v55
    v_mfma_f32_16x16x32_bf16 v[76:79], v[196:199], a[104:107], v[76:79]
    v_lshlrev_b32 v52, 16, v202
    v_and_b32 v53, 0xffff0000, v202
    v_mfma_f32_16x16x32_bf16 v[80:83], v[116:119], a[108:111], v[80:83]
    v_fma_f32 v52, v52, v46, v47
    v_fma_f32 v53, v53, v46, v47
    v_mfma_f32_16x16x32_bf16 v[84:87], v[196:199], a[108:111], v[84:87]
    v_cvt_pk_bf16_f32 v202, v52, v53
    v_lshlrev_b32 v54, 16, v203
    v_mfma_f32_16x16x32_bf16 v[88:91], v[116:119], a[112:115], v[88:91]
    v_and_b32 v55, 0xffff0000, v203
    v_fma_f32 v54, v54, v46, v47
    v_mfma_f32_16x16x32_bf16 v[92:95], v[196:199], a[112:115], v[92:95]
    v_fma_f32 v55, v55, v46, v47
    v_cvt_pk_bf16_f32 v203, v54, v55
    s_waitcnt lgkmcnt(0)
    v_mfma_f32_16x16x32_bf16 v[56:59], v[120:123], a[64:67], v[56:59]
    ds_read_b128 a[96:99], v6 offset:30720
    v_lshlrev_b32 v52, 16, v204
    v_and_b32 v53, 0xffff0000, v204
    v_mfma_f32_16x16x32_bf16 v[60:63], v[200:203], a[64:67], v[60:63]
    ds_read_b128 a[100:103], v6 offset:31744
    v_fma_f32 v52, v52, v46, v47
    v_fma_f32 v53, v53, v46, v47
    v_mfma_f32_16x16x32_bf16 v[64:67], v[120:123], a[68:71], v[64:67]
    ds_read_b128 a[104:107], v6 offset:32768
    v_cvt_pk_bf16_f32 v204, v52, v53
    v_lshlrev_b32 v54, 16, v205
    v_mfma_f32_16x16x32_bf16 v[68:71], v[200:203], a[68:71], v[68:71]
    ds_read_b128 a[108:111], v6 offset:33792
    v_and_b32 v55, 0xffff0000, v205
    v_fma_f32 v54, v54, v46, v47
    v_mfma_f32_16x16x32_bf16 v[72:75], v[120:123], a[72:75], v[72:75]
    ds_read_b128 a[112:115], v6 offset:34816
    v_fma_f32 v55, v55, v46, v47
    v_cvt_pk_bf16_f32 v205, v54, v55
    s_add_u32 m0, s18, 105472
    v_accvgpr_read_b32 v3, a235
    buffer_load_dwordx4 v3, s[56:59], s78 offen  lds
    v_mfma_f32_16x16x32_bf16 v[76:79], v[200:203], a[72:75], v[76:79]
    v_lshlrev_b32 v52, 16, v206
    v_and_b32 v53, 0xffff0000, v206
    v_mfma_f32_16x16x32_bf16 v[80:83], v[120:123], a[76:79], v[80:83]
    v_fma_f32 v52, v52, v46, v47
    v_fma_f32 v53, v53, v46, v47
    v_mfma_f32_16x16x32_bf16 v[84:87], v[200:203], a[76:79], v[84:87]
    v_cvt_pk_bf16_f32 v206, v52, v53
    v_lshlrev_b32 v54, 16, v207
    v_mfma_f32_16x16x32_bf16 v[88:91], v[120:123], a[80:83], v[88:91]
    v_and_b32 v55, 0xffff0000, v207
    v_fma_f32 v54, v54, v46, v47
    v_mfma_f32_16x16x32_bf16 v[92:95], v[200:203], a[80:83], v[92:95]
    v_fma_f32 v55, v55, v46, v47
    v_cvt_pk_bf16_f32 v207, v54, v55
    s_waitcnt lgkmcnt(0)
    v_mfma_f32_16x16x32_bf16 v[56:59], v[124:127], a[96:99], v[56:59]
    s_waitcnt vmcnt(15)
    s_barrier
    v_lshlrev_b32 v52, 16, v208
    v_and_b32 v53, 0xffff0000, v208
    v_mfma_f32_16x16x32_bf16 v[60:63], v[204:207], a[96:99], v[60:63]
    ds_read_b128 a[64:67], v5 offset:40960
    v_fma_f32 v52, v52, v46, v47
    v_fma_f32 v53, v53, v46, v47
    v_accvgpr_read_b32 v32, a200
    v_mfma_f32_16x16x32_bf16 v[64:67], v[124:127], a[100:103], v[64:67]
    ds_read_b128 a[68:71], v5 offset:41984
    v_cvt_pk_bf16_f32 v208, v52, v53
    v_lshlrev_b32 v54, 16, v209
    v_mfma_f32_16x16x32_bf16 v[68:71], v[204:207], a[100:103], v[68:71]
    ds_read_b128 a[72:75], v5 offset:43008
    v_and_b32 v55, 0xffff0000, v209
    v_fma_f32 v54, v54, v46, v47
    s_add_u32 m0, s18, 106496
    v_accvgpr_read_b32 v3, a236
    buffer_load_dwordx4 v3, s[56:59], s78 offen  lds
    v_mfma_f32_16x16x32_bf16 v[72:75], v[124:127], a[104:107], v[72:75]
    ds_read_b128 a[76:79], v5 offset:44032
    v_fma_f32 v55, v55, v46, v47
    v_cvt_pk_bf16_f32 v209, v54, v55
    v_accvgpr_read_b32 v33, a201
    v_mfma_f32_16x16x32_bf16 v[76:79], v[204:207], a[104:107], v[76:79]
    ds_read_b128 a[80:83], v5 offset:45056
    v_lshlrev_b32 v52, 16, v210
    v_and_b32 v53, 0xffff0000, v210
    v_mfma_f32_16x16x32_bf16 v[80:83], v[124:127], a[108:111], v[80:83]
    v_fma_f32 v52, v52, v46, v47
    v_fma_f32 v53, v53, v46, v47
    v_accvgpr_read_b32 v34, a202
    v_mfma_f32_16x16x32_bf16 v[84:87], v[204:207], a[108:111], v[84:87]
    v_cvt_pk_bf16_f32 v210, v52, v53
    v_lshlrev_b32 v54, 16, v211
    v_accvgpr_read_b32 v35, a203
    v_mfma_f32_16x16x32_bf16 v[88:91], v[124:127], a[112:115], v[88:91]
    v_and_b32 v55, 0xffff0000, v211
    v_fma_f32 v54, v54, v46, v47
    v_sub_f32 v35, 0, v35
    v_mfma_f32_16x16x32_bf16 v[92:95], v[204:207], a[112:115], v[92:95]
    v_fma_f32 v55, v55, v46, v47
    v_cvt_pk_bf16_f32 v211, v54, v55
    v_mov_b32 v36, v32
    s_waitcnt lgkmcnt(0)
    v_mfma_f32_16x16x32_bf16 v[56:59], v[128:131], a[64:67], v[56:59]
    ds_read_b128 a[96:99], v6 offset:40960
    v_lshlrev_b32 v52, 16, v212
    v_and_b32 v53, 0xffff0000, v212
    v_mfma_f32_16x16x32_bf16 v[60:63], v[208:211], a[64:67], v[60:63]
    ds_read_b128 a[100:103], v6 offset:41984
    v_fma_f32 v52, v52, v46, v47
    v_fma_f32 v53, v53, v46, v47
    s_add_u32 m0, s93, 0
    s_nop 0
    buffer_load_dwordx4 v13, s[44:47], s14 offen offset:0  lds
    v_mfma_f32_16x16x32_bf16 v[64:67], v[128:131], a[68:71], v[64:67]
    ds_read_b128 a[104:107], v6 offset:43008
    v_cvt_pk_bf16_f32 v212, v52, v53
    v_lshlrev_b32 v54, 16, v213
    v_mfma_f32_16x16x32_bf16 v[68:71], v[208:211], a[68:71], v[68:71]
    ds_read_b128 a[108:111], v6 offset:44032
    v_and_b32 v55, 0xffff0000, v213
    v_fma_f32 v54, v54, v46, v47
    v_mfma_f32_16x16x32_bf16 v[72:75], v[128:131], a[72:75], v[72:75]
    ds_read_b128 a[112:115], v6 offset:45056
    v_fma_f32 v55, v55, v46, v47
    v_cvt_pk_bf16_f32 v213, v54, v55
    buffer_load_dwordx4 v14, s[44:47], s14 offen offset:1024  lds
    v_mfma_f32_16x16x32_bf16 v[76:79], v[208:211], a[72:75], v[76:79]
    v_lshlrev_b32 v52, 16, v214
    v_and_b32 v53, 0xffff0000, v214
    v_sub_f32 v37, 0, v33
    v_mfma_f32_16x16x32_bf16 v[80:83], v[128:131], a[76:79], v[80:83]
    v_fma_f32 v52, v52, v46, v47
    v_fma_f32 v53, v53, v46, v47
    v_sub_f32 v38, 0, v34
    v_mfma_f32_16x16x32_bf16 v[84:87], v[208:211], a[76:79], v[84:87]
    v_cvt_pk_bf16_f32 v214, v52, v53
    v_lshlrev_b32 v54, 16, v215
    v_mov_b32 v39, v35
    v_mfma_f32_16x16x32_bf16 v[88:91], v[128:131], a[80:83], v[88:91]
    v_and_b32 v55, 0xffff0000, v215
    v_fma_f32 v54, v54, v46, v47
    ds_write_b128 v18, v[32:35] offset:0
    v_mfma_f32_16x16x32_bf16 v[92:95], v[208:211], a[80:83], v[92:95]
    v_fma_f32 v55, v55, v46, v47
    v_cvt_pk_bf16_f32 v215, v54, v55
    ds_write_b128 v18, v[36:39] offset:128
    s_waitcnt lgkmcnt(2)
    v_mfma_f32_16x16x32_bf16 v[56:59], v[132:135], a[96:99], v[56:59]
    ds_read_b128 a[64:67], v5 offset:51200
    v_lshlrev_b32 v52, 16, v216
    v_and_b32 v53, 0xffff0000, v216
    v_mfma_f32_16x16x32_bf16 v[60:63], v[212:215], a[96:99], v[60:63]
    ds_read_b128 a[68:71], v5 offset:52224
    v_fma_f32 v52, v52, v46, v47
    v_fma_f32 v53, v53, v46, v47
    buffer_load_dwordx4 v15, s[44:47], s14 offen offset:2048  lds
    v_mfma_f32_16x16x32_bf16 v[64:67], v[132:135], a[100:103], v[64:67]
    ds_read_b128 a[72:75], v5 offset:53248
    v_cvt_pk_bf16_f32 v216, v52, v53
    v_lshlrev_b32 v54, 16, v217
    v_mfma_f32_16x16x32_bf16 v[68:71], v[212:215], a[100:103], v[68:71]
    ds_read_b128 a[76:79], v5 offset:54272
    v_and_b32 v55, 0xffff0000, v217
    v_fma_f32 v54, v54, v46, v47
    v_mfma_f32_16x16x32_bf16 v[72:75], v[132:135], a[104:107], v[72:75]
    ds_read_b128 a[80:83], v5 offset:55296
    v_fma_f32 v55, v55, v46, v47
    v_cvt_pk_bf16_f32 v217, v54, v55
    buffer_load_dwordx4 v16, s[44:47], s14 offen offset:3072  lds
    v_mfma_f32_16x16x32_bf16 v[76:79], v[212:215], a[104:107], v[76:79]
    v_lshlrev_b32 v52, 16, v218
    v_and_b32 v53, 0xffff0000, v218
    ds_write_b128 v20, a[204:207] offset:1280
    v_mfma_f32_16x16x32_bf16 v[80:83], v[132:135], a[108:111], v[80:83]
    v_fma_f32 v52, v52, v46, v47
    v_fma_f32 v53, v53, v46, v47
    ds_write_b128 v20, a[208:211] offset:2304
    v_mfma_f32_16x16x32_bf16 v[84:87], v[212:215], a[108:111], v[84:87]
    v_cvt_pk_bf16_f32 v218, v52, v53
    v_lshlrev_b32 v54, 16, v219
    ds_write_b64 v20, a[212:213] offset:3328
    v_mfma_f32_16x16x32_bf16 v[88:91], v[132:135], a[112:115], v[88:91]
    v_and_b32 v55, 0xffff0000, v219
    v_fma_f32 v54, v54, v46, v47
    v_mov_b32 v32, 0
    v_mfma_f32_16x16x32_bf16 v[92:95], v[212:215], a[112:115], v[92:95]
    v_fma_f32 v55, v55, v46, v47
    v_cvt_pk_bf16_f32 v219, v54, v55
    v_mov_b32 v33, 0
    s_waitcnt lgkmcnt(3)
    v_mfma_f32_16x16x32_bf16 v[56:59], v[136:139], a[64:67], v[56:59]
    ds_read_b128 a[96:99], v6 offset:51200
    v_lshlrev_b32 v52, 16, v220
    v_and_b32 v53, 0xffff0000, v220
    v_mfma_f32_16x16x32_bf16 v[60:63], v[216:219], a[64:67], v[60:63]
    ds_read_b128 a[100:103], v6 offset:52224
    v_fma_f32 v52, v52, v46, v47
    v_fma_f32 v53, v53, v46, v47
    s_add_u32 m0, s93, 16384
    s_add_u32 s4, s14, 196608
    buffer_load_dwordx4 v13, s[44:47], s4 offen offset:0  lds
    v_mfma_f32_16x16x32_bf16 v[64:67], v[136:139], a[68:71], v[64:67]
    ds_read_b128 a[104:107], v6 offset:53248
    v_cvt_pk_bf16_f32 v220, v52, v53
    v_lshlrev_b32 v54, 16, v221
    v_mfma_f32_16x16x32_bf16 v[68:71], v[216:219], a[68:71], v[68:71]
    ds_read_b128 a[108:111], v6 offset:54272
    v_and_b32 v55, 0xffff0000, v221
    v_fma_f32 v54, v54, v46, v47
    v_mfma_f32_16x16x32_bf16 v[72:75], v[136:139], a[72:75], v[72:75]
    ds_read_b128 a[112:115], v6 offset:55296
    v_fma_f32 v55, v55, v46, v47
    v_cvt_pk_bf16_f32 v221, v54, v55
    v_mfma_f32_16x16x32_bf16 v[76:79], v[216:219], a[72:75], v[76:79]
    v_lshlrev_b32 v52, 16, v222
    v_and_b32 v53, 0xffff0000, v222
    buffer_load_dwordx4 v14, s[44:47], s4 offen offset:1024  lds
    v_mfma_f32_16x16x32_bf16 v[80:83], v[136:139], a[76:79], v[80:83]
    v_fma_f32 v52, v52, v46, v47
    v_fma_f32 v53, v53, v46, v47
    s_min_u32 s72, s64, 2
    v_mfma_f32_16x16x32_bf16 v[84:87], v[216:219], a[76:79], v[84:87]
    v_cvt_pk_bf16_f32 v222, v52, v53
    v_lshlrev_b32 v54, 16, v223
    s_lshl_b32 s72, s72, 9
    v_mfma_f32_16x16x32_bf16 v[88:91], v[136:139], a[80:83], v[88:91]
    v_and_b32 v55, 0xffff0000, v223
    v_fma_f32 v54, v54, v46, v47
    s_add_u32 s72, s72, 155648
    v_mfma_f32_16x16x32_bf16 v[92:95], v[216:219], a[80:83], v[92:95]
    v_fma_f32 v55, v55, v46, v47
    v_cvt_pk_bf16_f32 v223, v54, v55
    v_lshl_add_u32 v34, v1, 3, s72
    v_add_u32 v5, 61440, v5
    s_waitcnt lgkmcnt(0)
    v_mfma_f32_16x16x32_bf16 v[56:59], v[140:143], a[96:99], v[56:59]
    s_waitcnt vmcnt(16)
    s_barrier
    v_lshlrev_b32 v52, 16, v224
    v_and_b32 v53, 0xffff0000, v224
    v_mfma_f32_16x16x32_bf16 v[60:63], v[220:223], a[96:99], v[60:63]
    ds_read_b128 a[64:67], v5 offset:0
    v_fma_f32 v52, v52, v46, v47
    v_fma_f32 v53, v53, v46, v47
    buffer_load_dwordx4 v15, s[44:47], s4 offen offset:2048  lds
    v_mfma_f32_16x16x32_bf16 v[64:67], v[140:143], a[100:103], v[64:67]
    ds_read_b128 a[68:71], v5 offset:1024
    v_cvt_pk_bf16_f32 v224, v52, v53
    v_lshlrev_b32 v54, 16, v225
    buffer_load_dwordx4 v16, s[44:47], s4 offen offset:3072  lds
    v_mfma_f32_16x16x32_bf16 v[68:71], v[220:223], a[100:103], v[68:71]
    ds_read_b128 a[72:75], v5 offset:2048
    v_and_b32 v55, 0xffff0000, v225
    v_fma_f32 v54, v54, v46, v47
    v_mfma_f32_16x16x32_bf16 v[72:75], v[140:143], a[104:107], v[72:75]
    ds_read_b128 a[76:79], v5 offset:3072
    v_fma_f32 v55, v55, v46, v47
    v_cvt_pk_bf16_f32 v225, v54, v55
    v_mfma_f32_16x16x32_bf16 v[76:79], v[220:223], a[104:107], v[76:79]
    ds_read_b128 a[80:83], v5 offset:4096
    v_lshlrev_b32 v52, 16, v226
    v_and_b32 v53, 0xffff0000, v226
    v_mfma_f32_16x16x32_bf16 v[80:83], v[140:143], a[108:111], v[80:83]
    v_fma_f32 v52, v52, v46, v47
    v_fma_f32 v53, v53, v46, v47
    ds_write_b64 v34, v[32:33]
    v_mfma_f32_16x16x32_bf16 v[84:87], v[220:223], a[108:111], v[84:87]
    v_cvt_pk_bf16_f32 v226, v52, v53
    v_lshlrev_b32 v54, 16, v227
    v_and_b32 v32, 12, v1
    v_mfma_f32_16x16x32_bf16 v[88:91], v[140:143], a[112:115], v[88:91]
    v_and_b32 v55, 0xffff0000, v227
    v_fma_f32 v54, v54, v46, v47
    s_add_u32 m0, s93, 32768
    s_nop 0
    buffer_load_dwordx4 v13, s[44:47], s15 offen offset:0  lds
    v_mfma_f32_16x16x32_bf16 v[92:95], v[220:223], a[112:115], v[92:95]
    v_fma_f32 v55, v55, v46, v47
    v_cvt_pk_bf16_f32 v227, v54, v55
    buffer_load_dwordx4 v14, s[44:47], s15 offen offset:1024  lds
    v_add_u32 v6, 61440, v6
    s_waitcnt lgkmcnt(1)
    v_mfma_f32_16x16x32_bf16 v[56:59], v[144:147], a[64:67], v[56:59]
    ds_read_b128 a[96:99], v6 offset:0
    v_lshlrev_b32 v52, 16, v228
    v_and_b32 v53, 0xffff0000, v228
    v_mfma_f32_16x16x32_bf16 v[60:63], v[224:227], a[64:67], v[60:63]
    ds_read_b128 a[100:103], v6 offset:1024
    v_fma_f32 v52, v52, v46, v47
    v_fma_f32 v53, v53, v46, v47
    buffer_load_dwordx4 v15, s[44:47], s15 offen offset:2048  lds
    v_mfma_f32_16x16x32_bf16 v[64:67], v[144:147], a[68:71], v[64:67]
    ds_read_b128 a[104:107], v6 offset:2048
    v_cvt_pk_bf16_f32 v228, v52, v53
    v_lshlrev_b32 v54, 16, v229
    buffer_load_dwordx4 v16, s[44:47], s15 offen offset:3072  lds
    v_mfma_f32_16x16x32_bf16 v[68:71], v[224:227], a[68:71], v[68:71]
    ds_read_b128 a[108:111], v6 offset:3072
    v_and_b32 v55, 0xffff0000, v229
    v_fma_f32 v54, v54, v46, v47
    v_mfma_f32_16x16x32_bf16 v[72:75], v[144:147], a[72:75], v[72:75]
    ds_read_b128 a[112:115], v6 offset:4096
    v_fma_f32 v55, v55, v46, v47
    v_cvt_pk_bf16_f32 v229, v54, v55
    v_mfma_f32_16x16x32_bf16 v[76:79], v[224:227], a[72:75], v[76:79]
    v_lshlrev_b32 v52, 16, v230
    v_and_b32 v53, 0xffff0000, v230
    v_add_u32 v32, v32, v1
    v_mfma_f32_16x16x32_bf16 v[80:83], v[144:147], a[76:79], v[80:83]
    v_fma_f32 v52, v52, v46, v47
    v_fma_f32 v53, v53, v46, v47
    v_lshlrev_b32 v32, 3, v32
    v_mfma_f32_16x16x32_bf16 v[84:87], v[224:227], a[76:79], v[84:87]
    v_cvt_pk_bf16_f32 v230, v52, v53
    v_lshlrev_b32 v54, 16, v231
    v_mov_b32 v33, 1073741824
    v_mfma_f32_16x16x32_bf16 v[88:91], v[144:147], a[80:83], v[88:91]
    v_and_b32 v55, 0xffff0000, v231
    v_fma_f32 v54, v54, v46, v47
    v_cmp_gt_u32 vcc, 16, v1
    s_nop 1
    v_cndmask_b32 v32, v33, v32, vcc
    v_mfma_f32_16x16x32_bf16 v[92:95], v[224:227], a[80:83], v[92:95]
    v_fma_f32 v55, v55, v46, v47
    v_cvt_pk_bf16_f32 v231, v54, v55
    buffer_store_dwordx2 v[44:45], v32, s[48:51], s99 offen offset:0 sc1
    s_waitcnt lgkmcnt(0)
    v_mfma_f32_16x16x32_bf16 v[56:59], v[148:151], a[96:99], v[56:59]
    ds_read_b128 a[64:67], v5 offset:10240
    v_lshlrev_b32 v52, 16, v232
    v_and_b32 v53, 0xffff0000, v232
    v_mfma_f32_16x16x32_bf16 v[60:63], v[228:231], a[96:99], v[60:63]
    ds_read_b128 a[68:71], v5 offset:11264
    v_fma_f32 v52, v52, v46, v47
    v_fma_f32 v53, v53, v46, v47
    v_mfma_f32_16x16x32_bf16 v[64:67], v[148:151], a[100:103], v[64:67]
    ds_read_b128 a[72:75], v5 offset:12288
    v_cvt_pk_bf16_f32 v232, v52, v53
    v_lshlrev_b32 v54, 16, v233
    v_mfma_f32_16x16x32_bf16 v[68:71], v[228:231], a[100:103], v[68:71]
    ds_read_b128 a[76:79], v5 offset:13312
    v_and_b32 v55, 0xffff0000, v233
    v_fma_f32 v54, v54, v46, v47
    v_mfma_f32_16x16x32_bf16 v[72:75], v[148:151], a[104:107], v[72:75]
    ds_read_b128 a[80:83], v5 offset:14336
    v_fma_f32 v55, v55, v46, v47
    v_cvt_pk_bf16_f32 v233, v54, v55
    v_mfma_f32_16x16x32_bf16 v[76:79], v[228:231], a[104:107], v[76:79]
    v_lshlrev_b32 v52, 16, v234
    v_and_b32 v53, 0xffff0000, v234
    buffer_store_dwordx2 v[46:47], v32, s[48:51], s99 offen offset:32 sc1
    v_mfma_f32_16x16x32_bf16 v[80:83], v[148:151], a[108:111], v[80:83]
    v_fma_f32 v52, v52, v46, v47
    v_fma_f32 v53, v53, v46, v47
    v_accvgpr_read_b32 v32, a237
    v_mfma_f32_16x16x32_bf16 v[84:87], v[228:231], a[108:111], v[84:87]
    v_cvt_pk_bf16_f32 v234, v52, v53
    v_lshlrev_b32 v54, 16, v235
    s_waitcnt vmcnt(14)
    s_cmp_eq_u32 s33, 1
    s_cbranch_scc0 L_rfw
    ds_read_b64 a[160:161], v32 offset:0
    ds_read_b64 a[162:163], v32 offset:8
    ds_read_b64 a[164:165], v32 offset:1024
    ds_read_b64 a[166:167], v32 offset:1032
    ds_read_b64 a[168:169], v32 offset:2048
    ds_read_b64 a[170:171], v32 offset:2056
    ds_read_b64 a[172:173], v32 offset:3072
    ds_read_b64 a[174:175], v32 offset:3080
    ds_read_b64 a[176:177], v32 offset:4096
    ds_read_b64 a[178:179], v32 offset:4104
    s_branch L_rfj
L_rfw:
    ds_read_b64_tr_b16 a[160:161], v32 offset:0
    ds_read_b64_tr_b16 a[162:163], v32 offset:1280
    ds_read_b64_tr_b16 a[164:165], v32 offset:32
    ds_read_b64_tr_b16 a[166:167], v32 offset:1312
    ds_read_b64_tr_b16 a[168:169], v32 offset:64
    ds_read_b64_tr_b16 a[170:171], v32 offset:1344
    ds_read_b64_tr_b16 a[172:173], v32 offset:96
    ds_read_b64_tr_b16 a[174:175], v32 offset:1376
    ds_read_b64_tr_b16 a[176:177], v32 offset:128
    ds_read_b64_tr_b16 a[178:179], v32 offset:1408
L_rfj:
    v_mfma_f32_16x16x32_bf16 v[88:91], v[148:151], a[112:115], v[88:91]
    v_and_b32 v55, 0xffff0000, v235
    v_fma_f32 v54, v54, v46, v47
    v_mfma_f32_16x16x32_bf16 v[92:95], v[228:231], a[112:115], v[92:95]
    v_fma_f32 v55, v55, v46, v47
    v_cvt_pk_bf16_f32 v235, v54, v55
    s_waitcnt lgkmcnt(10)
    v_mfma_f32_16x16x32_bf16 v[56:59], v[152:155], a[64:67], v[56:59]
    ds_read_b128 a[96:99], v6 offset:10240
    v_lshlrev_b32 v52, 16, v236
    v_and_b32 v53, 0xffff0000, v236
    v_mfma_f32_16x16x32_bf16 v[60:63], v[232:235], a[64:67], v[60:63]
    ds_read_b128 a[100:103], v6 offset:11264
    v_fma_f32 v52, v52, v46, v47
    v_fma_f32 v53, v53, v46, v47
    v_mfma_f32_16x16x32_bf16 v[64:67], v[152:155], a[68:71], v[64:67]
    ds_read_b128 a[104:107], v6 offset:12288
    v_cvt_pk_bf16_f32 v236, v52, v53
    v_lshlrev_b32 v54, 16, v237
    v_mfma_f32_16x16x32_bf16 v[68:71], v[232:235], a[68:71], v[68:71]
    ds_read_b128 a[108:111], v6 offset:13312
    v_and_b32 v55, 0xffff0000, v237
    v_fma_f32 v54, v54, v46, v47
    v_mfma_f32_16x16x32_bf16 v[72:75], v[152:155], a[72:75], v[72:75]
    ds_read_b128 a[112:115], v6 offset:14336
    v_fma_f32 v55, v55, v46, v47
    v_cvt_pk_bf16_f32 v237, v54, v55
    v_mfma_f32_16x16x32_bf16 v[76:79], v[232:235], a[72:75], v[76:79]
    v_lshlrev_b32 v52, 16, v238
    v_and_b32 v53, 0xffff0000, v238
    s_waitcnt lgkmcnt(13)
    buffer_store_dwordx4 a[160:163], v2, s[48:51], s79 offen offset:0 sc1
    v_mfma_f32_16x16x32_bf16 v[80:83], v[152:155], a[76:79], v[80:83]
    v_fma_f32 v52, v52, v46, v47
    v_fma_f32 v53, v53, v46, v47
    v_mfma_f32_16x16x32_bf16 v[84:87], v[232:235], a[76:79], v[84:87]
    v_cvt_pk_bf16_f32 v238, v52, v53
    v_lshlrev_b32 v54, 16, v239
    v_mfma_f32_16x16x32_bf16 v[88:91], v[152:155], a[80:83], v[88:91]
    v_and_b32 v55, 0xffff0000, v239
    v_fma_f32 v54, v54, v46, v47
    v_mfma_f32_16x16x32_bf16 v[92:95], v[232:235], a[80:83], v[92:95]
    v_fma_f32 v55, v55, v46, v47
    v_cvt_pk_bf16_f32 v239, v54, v55
    s_waitcnt lgkmcnt(0)
    v_mfma_f32_16x16x32_bf16 v[56:59], v[156:159], a[96:99], v[56:59]
    s_barrier
    v_lshlrev_b32 v52, 16, v240
    v_and_b32 v53, 0xffff0000, v240
    v_mfma_f32_16x16x32_bf16 v[60:63], v[236:239], a[96:99], v[60:63]
    ds_read_b128 a[64:67], v5 offset:20480
    v_fma_f32 v52, v52, v46, v47
    v_fma_f32 v53, v53, v46, v47
    buffer_load_dwordx2 v[30:31], off, s[60:63], 0 sc1
    v_mfma_f32_16x16x32_bf16 v[64:67], v[156:159], a[100:103], v[64:67]
    ds_read_b128 a[68:71], v5 offset:21504
    v_cvt_pk_bf16_f32 v240, v52, v53
    v_lshlrev_b32 v54, 16, v241
    v_mfma_f32_16x16x32_bf16 v[68:71], v[236:239], a[100:103], v[68:71]
    ds_read_b128 a[72:75], v5 offset:22528
    v_and_b32 v55, 0xffff0000, v241
    v_fma_f32 v54, v54, v46, v47
    v_mfma_f32_16x16x32_bf16 v[72:75], v[156:159], a[104:107], v[72:75]
    ds_read_b128 a[76:79], v5 offset:23552
    v_fma_f32 v55, v55, v46, v47
    v_cvt_pk_bf16_f32 v241, v54, v55
    v_mfma_f32_16x16x32_bf16 v[76:79], v[236:239], a[104:107], v[76:79]
    ds_read_b128 a[80:83], v5 offset:24576
    v_lshlrev_b32 v52, 16, v242
    v_and_b32 v53, 0xffff0000, v242
    v_mfma_f32_16x16x32_bf16 v[80:83], v[156:159], a[108:111], v[80:83]
    v_fma_f32 v52, v52, v46, v47
    v_fma_f32 v53, v53, v46, v47
    v_mfma_f32_16x16x32_bf16 v[84:87], v[236:239], a[108:111], v[84:87]
    v_cvt_pk_bf16_f32 v242, v52, v53
    v_lshlrev_b32 v54, 16, v243
    v_mfma_f32_16x16x32_bf16 v[88:91], v[156:159], a[112:115], v[88:91]
    v_and_b32 v55, 0xffff0000, v243
    v_fma_f32 v54, v54, v46, v47
    v_mfma_f32_16x16x32_bf16 v[92:95], v[236:239], a[112:115], v[92:95]
    v_fma_f32 v55, v55, v46, v47
    v_cvt_pk_bf16_f32 v243, v54, v55
    s_waitcnt lgkmcnt(0)
    v_mfma_f32_16x16x32_bf16 v[56:59], v[160:163], a[64:67], v[56:59]
    ds_read_b128 a[96:99], v6 offset:20480
    v_lshlrev_b32 v52, 16, v244
    v_and_b32 v53, 0xffff0000, v244
    v_mfma_f32_16x16x32_bf16 v[60:63], v[240:243], a[64:67], v[60:63]
    ds_read_b128 a[100:103], v6 offset:21504
    v_fma_f32 v52, v52, v46, v47
    v_fma_f32 v53, v53, v46, v47
    v_mfma_f32_16x16x32_bf16 v[64:67], v[160:163], a[68:71], v[64:67]
    ds_read_b128 a[104:107], v6 offset:22528
    v_cvt_pk_bf16_f32 v244, v52, v53
    v_lshlrev_b32 v54, 16, v245
    v_mfma_f32_16x16x32_bf16 v[68:71], v[240:243], a[68:71], v[68:71]
    ds_read_b128 a[108:111], v6 offset:23552
    v_and_b32 v55, 0xffff0000, v245
    v_fma_f32 v54, v54, v46, v47
    v_mfma_f32_16x16x32_bf16 v[72:75], v[160:163], a[72:75], v[72:75]
    ds_read_b128 a[112:115], v6 offset:24576
    v_fma_f32 v55, v55, v46, v47
    v_cvt_pk_bf16_f32 v245, v54, v55
    v_mfma_f32_16x16x32_bf16 v[76:79], v[240:243], a[72:75], v[76:79]
    v_lshlrev_b32 v52, 16, v246
    v_and_b32 v53, 0xffff0000, v246
    buffer_store_dwordx4 a[164:167], v2, s[48:51], s79 offen offset:1024 sc1
    v_mfma_f32_16x16x32_bf16 v[80:83], v[160:163], a[76:79], v[80:83]
    v_fma_f32 v52, v52, v46, v47
    v_fma_f32 v53, v53, v46, v47
    buffer_store_dwordx4 a[168:171], v2, s[48:51], s79 offen offset:2048 sc1
    v_mfma_f32_16x16x32_bf16 v[84:87], v[240:243], a[76:79], v[84:87]
    v_cvt_pk_bf16_f32 v246, v52, v53
    v_lshlrev_b32 v54, 16, v247
    v_mfma_f32_16x16x32_bf16 v[88:91], v[160:163], a[80:83], v[88:91]
    v_and_b32 v55, 0xffff0000, v247
    v_fma_f32 v54, v54, v46, v47
    buffer_store_dwordx4 a[172:175], v2, s[48:51], s79 offen offset:3072 sc1
    v_mfma_f32_16x16x32_bf16 v[92:95], v[240:243], a[80:83], v[92:95]
    v_fma_f32 v55, v55, v46, v47
    v_cvt_pk_bf16_f32 v247, v54, v55
    s_waitcnt lgkmcnt(0)
    v_mfma_f32_16x16x32_bf16 v[56:59], v[164:167], a[96:99], v[56:59]
    ds_read_b128 a[64:67], v5 offset:30720
    v_lshlrev_b32 v52, 16, v248
    v_and_b32 v53, 0xffff0000, v248
    v_mfma_f32_16x16x32_bf16 v[60:63], v[244:247], a[96:99], v[60:63]
    ds_read_b128 a[68:71], v5 offset:31744
    v_fma_f32 v52, v52, v46, v47
    v_fma_f32 v53, v53, v46, v47
    v_mfma_f32_16x16x32_bf16 v[64:67], v[164:167], a[100:103], v[64:67]
    ds_read_b128 a[72:75], v5 offset:32768
    v_cvt_pk_bf16_f32 v248, v52, v53
    v_lshlrev_b32 v54, 16, v249
    v_mfma_f32_16x16x32_bf16 v[68:71], v[244:247], a[100:103], v[68:71]
    ds_read_b128 a[76:79], v5 offset:33792
    v_and_b32 v55, 0xffff0000, v249
    v_fma_f32 v54, v54, v46, v47
    v_mfma_f32_16x16x32_bf16 v[72:75], v[164:167], a[104:107], v[72:75]
    ds_read_b128 a[80:83], v5 offset:34816
    v_fma_f32 v55, v55, v46, v47
    v_cvt_pk_bf16_f32 v249, v54, v55
    v_mfma_f32_16x16x32_bf16 v[76:79], v[244:247], a[104:107], v[76:79]
    v_lshlrev_b32 v52, 16, v250
    v_and_b32 v53, 0xffff0000, v250
    buffer_store_dwordx4 a[176:179], v12, s[48:51], s79 offen sc1
    v_mfma_f32_16x16x32_bf16 v[80:83], v[164:167], a[108:111], v[80:83]
    v_fma_f32 v52, v52, v46, v47
    v_fma_f32 v53, v53, v46, v47
    v_mfma_f32_16x16x32_bf16 v[84:87], v[244:247], a[108:111], v[84:87]
    v_cvt_pk_bf16_f32 v250, v52, v53
    v_lshlrev_b32 v54, 16, v251
    v_mfma_f32_16x16x32_bf16 v[88:91], v[164:167], a[112:115], v[88:91]
    v_and_b32 v55, 0xffff0000, v251
    v_fma_f32 v54, v54, v46, v47
    v_mfma_f32_16x16x32_bf16 v[92:95], v[244:247], a[112:115], v[92:95]
    v_fma_f32 v55, v55, v46, v47
    v_cvt_pk_bf16_f32 v251, v54, v55
    s_waitcnt lgkmcnt(0)
    v_mfma_f32_16x16x32_bf16 v[56:59], v[168:171], a[64:67], v[56:59]
    ds_read_b128 a[96:99], v6 offset:30720
    v_lshlrev_b32 v52, 16, v252
    v_and_b32 v53, 0xffff0000, v252
    v_mfma_f32_16x16x32_bf16 v[60:63], v[248:251], a[64:67], v[60:63]
    ds_read_b128 a[100:103], v6 offset:31744
    v_fma_f32 v52, v52, v46, v47
    v_fma_f32 v53, v53, v46, v47
    v_mfma_f32_16x16x32_bf16 v[64:67], v[168:171], a[68:71], v[64:67]
    ds_read_b128 a[104:107], v6 offset:32768
    v_cvt_pk_bf16_f32 v252, v52, v53
    v_lshlrev_b32 v54, 16, v253
    v_mfma_f32_16x16x32_bf16 v[68:71], v[248:251], a[68:71], v[68:71]
    ds_read_b128 a[108:111], v6 offset:33792
    v_and_b32 v55, 0xffff0000, v253
    v_fma_f32 v54, v54, v46, v47
    v_mfma_f32_16x16x32_bf16 v[72:75], v[168:171], a[72:75], v[72:75]
    ds_read_b128 a[112:115], v6 offset:34816
    v_fma_f32 v55, v55, v46, v47
    v_cvt_pk_bf16_f32 v253, v54, v55
    v_mfma_f32_16x16x32_bf16 v[76:79], v[248:251], a[72:75], v[76:79]
    v_lshlrev_b32 v52, 16, v254
    v_and_b32 v53, 0xffff0000, v254
    v_mfma_f32_16x16x32_bf16 v[80:83], v[168:171], a[76:79], v[80:83]
    v_fma_f32 v52, v52, v46, v47
    v_fma_f32 v53, v53, v46, v47
    v_mfma_f32_16x16x32_bf16 v[84:87], v[248:251], a[76:79], v[84:87]
    v_cvt_pk_bf16_f32 v254, v52, v53
    v_lshlrev_b32 v54, 16, v255
    v_mfma_f32_16x16x32_bf16 v[88:91], v[168:171], a[80:83], v[88:91]
    v_and_b32 v55, 0xffff0000, v255
    v_fma_f32 v54, v54, v46, v47
    v_mfma_f32_16x16x32_bf16 v[92:95], v[248:251], a[80:83], v[92:95]
    v_fma_f32 v55, v55, v46, v47
    v_cvt_pk_bf16_f32 v255, v54, v55
    s_waitcnt lgkmcnt(0)
    v_mfma_f32_16x16x32_bf16 v[56:59], v[172:175], a[96:99], v[56:59]
    s_waitcnt vmcnt(16)
    s_barrier
    v_mfma_f32_16x16x32_bf16 v[60:63], v[252:255], a[96:99], v[60:63]
    ds_read_b64_tr_b16 a[64:65], v7 offset:0
    ds_read_b64_tr_b16 a[66:67], v7 offset:512
    ds_read_b64_tr_b16 a[68:69], v7 offset:4096
    s_add_u32 m0, s93, 49152
    s_add_u32 s4, s15, 196608
    buffer_load_dwordx4 v13, s[44:47], s4 offen offset:0  lds
    v_mfma_f32_16x16x32_bf16 v[64:67], v[172:175], a[100:103], v[64:67]
    ds_read_b64_tr_b16 a[70:71], v7 offset:4608
    ds_read_b64_tr_b16 a[72:73], v8 offset:0
    buffer_load_dwordx4 v14, s[44:47], s4 offen offset:1024  lds
    v_mfma_f32_16x16x32_bf16 v[68:71], v[252:255], a[100:103], v[68:71]
    ds_read_b64_tr_b16 a[74:75], v8 offset:512
    ds_read_b64_tr_b16 a[76:77], v8 offset:4096
    v_mfma_f32_16x16x32_bf16 v[72:75], v[172:175], a[104:107], v[72:75]
    ds_read_b64_tr_b16 a[78:79], v8 offset:4608
    ds_read_b64_tr_b16 a[80:81], v7 offset:1024
    ds_read_b64_tr_b16 a[82:83], v7 offset:1536
    buffer_load_dwordx4 v15, s[44:47], s4 offen offset:2048  lds
    v_mfma_f32_16x16x32_bf16 v[76:79], v[252:255], a[104:107], v[76:79]
    ds_read_b64_tr_b16 a[84:85], v7 offset:5120
    ds_read_b64_tr_b16 a[86:87], v7 offset:5632
    v_permlane16_swap_b32 v96, v176
    buffer_load_dwordx4 v16, s[44:47], s4 offen offset:3072  lds
    v_mfma_f32_16x16x32_bf16 v[80:83], v[172:175], a[108:111], v[80:83]
    ds_read_b64_tr_b16 a[88:89], v8 offset:1024
    ds_read_b64_tr_b16 a[90:91], v8 offset:1536
    v_permlane16_swap_b32 v97, v177
    v_lshrrev_b32 v4, 2, v1
    v_and_b32 v5, 3, v1
    v_lshlrev_b32 v5, 4, v5
    v_mul_u32_u24 v4, 3072, v4
    v_add_u32 v3, v4, v5
    v_add_u32 v4, 48128, v3
    v_add_u32 v5, 96256, v3
    v_add_u32 v6, 144384, v3
    v_add_u32 v11, 0x10000, v9
    v_mfma_f32_16x16x32_bf16 v[84:87], v[252:255], a[108:111], v[84:87]
    ds_read_b64_tr_b16 a[92:93], v8 offset:5120
    ds_read_b64_tr_b16 a[94:95], v8 offset:5632
    v_permlane16_swap_b32 v98, v178
    v_mfma_f32_16x16x32_bf16 v[88:91], v[172:175], a[112:115], v[88:91]
    v_permlane16_swap_b32 v99, v179
    v_mfma_f32_16x16x32_bf16 v[92:95], v[252:255], a[112:115], v[92:95]
    s_waitcnt lgkmcnt(0)
    v_mfma_f32_32x32x16_bf16 a[0:15], a[64:67], v[96:99], 0
    ds_read_b64_tr_b16 a[96:97], v7 offset:8192
    ds_read_b64_tr_b16 a[98:99], v7 offset:8704
    ds_read_b64_tr_b16 a[100:101], v7 offset:12288
    ds_read_b64_tr_b16 a[102:103], v7 offset:12800
    s_waitcnt vmcnt(8)
    v_cmp_ne_u32 vcc, 1, v31
    s_cbranch_vccz L_ok1
    s_mov_b32 s94, 262144
L_rt1:
    s_sleep 1
    buffer_load_dwordx2 v[30:31], off, s[60:63], 0 sc1
    s_waitcnt vmcnt(0)
    s_nop 1
    v_cmp_ne_u32 vcc, 1, v31
    s_cbranch_vccz L_ok1
    s_sub_u32 s94, s94, 1
    s_cmp_lg_u32 s94, 0
    s_cbranch_scc1 L_rt1
    s_nop 7
L_ok1:
    v_mfma_f32_32x32x16_bf16 a[32:47], a[68:71], v[96:99], 0
    ds_read_b64_tr_b16 a[104:105], v8 offset:8192
    ds_read_b64_tr_b16 a[106:107], v8 offset:8704
    ds_read_b64_tr_b16 a[108:109], v8 offset:12288
    s_add_u32 m0, s93, 65536
    s_add_u32 s31, s14, s77
    buffer_load_dwordx4 v3, s[44:47], s31 offen offset:0  lds
    v_mfma_f32_32x32x16_bf16 a[16:31], a[72:75], v[96:99], 0
    ds_read_b64_tr_b16 a[110:111], v8 offset:12800
    ds_read_b64_tr_b16 a[112:113], v7 offset:9216
    ds_read_b64_tr_b16 a[114:115], v7 offset:9728
    v_readfirstlane_b32 s69, v30
    v_mfma_f32_32x32x16_bf16 a[48:63], a[76:79], v[96:99], 0
    ds_read_b64_tr_b16 a[116:117], v7 offset:13312
    ds_read_b64_tr_b16 a[118:119], v7 offset:13824
    ds_read_b64_tr_b16 a[120:121], v8 offset:9216
    v_permlane16_swap_b32 v100, v180
    v_mfma_f32_32x32x16_bf16 a[0:15], a[80:83], v[176:179], a[0:15]
    ds_read_b64_tr_b16 a[122:123], v8 offset:9728
    ds_read_b64_tr_b16 a[124:125], v8 offset:13312
    ds_read_b64_tr_b16 a[126:127], v8 offset:13824
    v_permlane16_swap_b32 v101, v181
    v_mfma_f32_32x32x16_bf16 a[32:47], a[84:87], v[176:179], a[32:47]
    v_permlane16_swap_b32 v102, v182
    ds_read_b128 v[32:35], v19 offset:0
    ds_read_b128 v[36:39], v19 offset:256
    ds_read_b128 v[40:43], v19 offset:512
    v_mfma_f32_32x32x16_bf16 a[16:31], a[88:91], v[176:179], a[16:31]
    v_permlane16_swap_b32 v103, v183
    ds_read_b128 v[44:47], v19 offset:768
    ds_read_b128 v[48:51], v19 offset:1024
    v_mfma_f32_32x32x16_bf16 a[48:63], a[92:95], v[176:179], a[48:63]
    buffer_load_dwordx4 v4, s[44:47], s31 offen offset:1024  lds
    s_waitcnt lgkmcnt(5)
    v_mfma_f32_32x32x16_bf16 a[0:15], a[96:99], v[100:103], a[0:15]
    s_waitcnt lgkmcnt(0)
    s_barrier
    v_mfma_f32_32x32x16_bf16 a[32:47], a[100:103], v[100:103], a[32:47]
    ds_read_b64_tr_b16 a[64:65], v7 offset:16384
    ds_read_b64_tr_b16 a[66:67], v7 offset:16896
    ds_read_b64_tr_b16 a[68:69], v7 offset:20480
    ds_read_b64_tr_b16 a[70:71], v7 offset:20992
    v_mul_f32_dpp v52, v56, v35 row_ror:8 row_mask:0xf bank_mask:0xf
    v_fma_f32 v56, v34, v56, v52
    v_mul_f32_dpp v53, v64, v39 row_ror:8 row_mask:0xf bank_mask:0xf
    v_fma_f32 v64, v38, v64, v53
    v_mul_f32_dpp v54, v72, v43 row_ror:8 row_mask:0xf bank_mask:0xf
    v_fma_f32 v72, v42, v72, v54
    v_mul_f32_dpp v55, v80, v47 row_ror:8 row_mask:0xf bank_mask:0xf
    v_fma_f32 v80, v46, v80, v55
    v_mul_f32_dpp v52, v88, v51 row_ror:8 row_mask:0xf bank_mask:0xf
    v_fma_f32 v88, v50, v88, v52
    v_mul_f32_dpp v53, v57, v35 row_ror:8 row_mask:0xf bank_mask:0xf
    v_fma_f32 v57, v34, v57, v53
    v_mfma_f32_32x32x16_bf16 a[16:31], a[104:107], v[100:103], a[16:31]
    ds_read_b64_tr_b16 a[72:73], v8 offset:16384
    ds_read_b64_tr_b16 a[74:75], v8 offset:16896
    ds_read_b64_tr_b16 a[76:77], v8 offset:20480
    s_add_u32 m0, s93, 0
    s_nop 0
    buffer_load_dwordx4 v13, s[44:47], s16 offen offset:0  lds
    v_mul_f32_dpp v54, v65, v39 row_ror:8 row_mask:0xf bank_mask:0xf
    v_fma_f32 v65, v38, v65, v54
    v_mul_f32_dpp v55, v73, v43 row_ror:8 row_mask:0xf bank_mask:0xf
    v_fma_f32 v73, v42, v73, v55
    v_mul_f32_dpp v52, v81, v47 row_ror:8 row_mask:0xf bank_mask:0xf
    v_fma_f32 v81, v46, v81, v52
    v_mfma_f32_32x32x16_bf16 a[48:63], a[108:111], v[100:103], a[48:63]
    ds_read_b64_tr_b16 a[78:79], v8 offset:20992
    ds_read_b64_tr_b16 a[80:81], v7 offset:17408
    ds_read_b64_tr_b16 a[82:83], v7 offset:17920
    v_permlane16_swap_b32 v104, v184
    buffer_load_dwordx4 v14, s[44:47], s16 offen offset:1024  lds
    v_mul_f32_dpp v53, v89, v51 row_ror:8 row_mask:0xf bank_mask:0xf
    v_fma_f32 v89, v50, v89, v53
    v_mul_f32_dpp v54, v58, v35 row_ror:8 row_mask:0xf bank_mask:0xf
    v_fma_f32 v58, v34, v58, v54
    v_mul_f32_dpp v55, v66, v39 row_ror:8 row_mask:0xf bank_mask:0xf
    v_fma_f32 v66, v38, v66, v55
    v_mul_f32_dpp v52, v74, v43 row_ror:8 row_mask:0xf bank_mask:0xf
    v_mfma_f32_32x32x16_bf16 a[0:15], a[112:115], v[180:183], a[0:15]
    ds_read_b64_tr_b16 a[84:85], v7 offset:21504
    ds_read_b64_tr_b16 a[86:87], v7 offset:22016
    ds_read_b64_tr_b16 a[88:89], v8 offset:17408
    v_permlane16_swap_b32 v105, v185
    v_fma_f32 v74, v42, v74, v52
    v_mul_f32_dpp v53, v82, v47 row_ror:8 row_mask:0xf bank_mask:0xf
    v_fma_f32 v82, v46, v82, v53
    v_mul_f32_dpp v54, v90, v51 row_ror:8 row_mask:0xf bank_mask:0xf
    v_fma_f32 v90, v50, v90, v54
    v_mul_f32_dpp v55, v59, v35 row_ror:8 row_mask:0xf bank_mask:0xf
    v_mfma_f32_32x32x16_bf16 a[32:47], a[116:119], v[180:183], a[32:47]
    ds_read_b64_tr_b16 a[90:91], v8 offset:17920
    ds_read_b64_tr_b16 a[92:93], v8 offset:21504
    ds_read_b64_tr_b16 a[94:95], v8 offset:22016
    v_permlane16_swap_b32 v106, v186
    buffer_load_dwordx4 v15, s[44:47], s16 offen offset:2048  lds
    v_fma_f32 v59, v34, v59, v55
    v_mul_f32_dpp v52, v67, v39 row_ror:8 row_mask:0xf bank_mask:0xf
    v_fma_f32 v67, v38, v67, v52
    v_mul_f32_dpp v53, v75, v43 row_ror:8 row_mask:0xf bank_mask:0xf
    v_fma_f32 v75, v42, v75, v53
    v_mul_f32_dpp v54, v83, v47 row_ror:8 row_mask:0xf bank_mask:0xf
    v_fma_f32 v83, v46, v83, v54
    v_mfma_f32_32x32x16_bf16 a[16:31], a[120:123], v[180:183], a[16:31]
    v_permlane16_swap_b32 v107, v187
    buffer_load_dwordx4 v16, s[44:47], s16 offen offset:3072  lds
    v_mul_f32_dpp v55, v91, v51 row_ror:8 row_mask:0xf bank_mask:0xf
    v_fma_f32 v91, v50, v91, v55
    v_mul_f32_dpp v52, v60, v35 row_ror:8 row_mask:0xf bank_mask:0xf
    v_fma_f32 v60, v34, v60, v52
    v_mul_f32_dpp v53, v68, v39 row_ror:8 row_mask:0xf bank_mask:0xf
    v_fma_f32 v68, v38, v68, v53
    v_mul_f32_dpp v54, v76, v43 row_ror:8 row_mask:0xf bank_mask:0xf
    v_mfma_f32_32x32x16_bf16 a[48:63], a[124:127], v[180:183], a[48:63]
    v_fma_f32 v76, v42, v76, v54
    v_mul_f32_dpp v55, v84, v47 row_ror:8 row_mask:0xf bank_mask:0xf
    v_fma_f32 v84, v46, v84, v55
    v_mul_f32_dpp v52, v92, v51 row_ror:8 row_mask:0xf bank_mask:0xf
    v_fma_f32 v92, v50, v92, v52
    v_mul_f32_dpp v53, v61, v35 row_ror:8 row_mask:0xf bank_mask:0xf
    s_waitcnt lgkmcnt(0)
    v_mfma_f32_32x32x16_bf16 a[0:15], a[64:67], v[104:107], a[0:15]
    ds_read_b64_tr_b16 a[96:97], v7 offset:24576
    ds_read_b64_tr_b16 a[98:99], v7 offset:25088
    ds_read_b64_tr_b16 a[100:101], v7 offset:28672
    ds_read_b64_tr_b16 a[102:103], v7 offset:29184
    v_fma_f32 v61, v34, v61, v53
    v_mul_f32_dpp v54, v69, v39 row_ror:8 row_mask:0xf bank_mask:0xf
    v_fma_f32 v69, v38, v69, v54
    v_mul_f32_dpp v55, v77, v43 row_ror:8 row_mask:0xf bank_mask:0xf
    v_fma_f32 v77, v42, v77, v55
    v_mul_f32_dpp v52, v85, v47 row_ror:8 row_mask:0xf bank_mask:0xf
    v_fma_f32 v85, v46, v85, v52
    v_mfma_f32_32x32x16_bf16 a[32:47], a[68:71], v[104:107], a[32:47]
    ds_read_b64_tr_b16 a[104:105], v8 offset:24576
    ds_read_b64_tr_b16 a[106:107], v8 offset:25088
    ds_read_b64_tr_b16 a[108:109], v8 offset:28672
    s_add_u32 m0, s93, 65536
    s_nop 0
    buffer_load_dwordx4 v5, s[44:47], s31 offen offset:2048  lds
    v_mul_f32_dpp v53, v93, v51 row_ror:8 row_mask:0xf bank_mask:0xf
    v_fma_f32 v93, v50, v93, v53
    v_mul_f32_dpp v54, v62, v35 row_ror:8 row_mask:0xf bank_mask:0xf
    v_fma_f32 v62, v34, v62, v54
    v_mul_f32_dpp v55, v70, v39 row_ror:8 row_mask:0xf bank_mask:0xf
    v_fma_f32 v70, v38, v70, v55
    v_mfma_f32_32x32x16_bf16 a[16:31], a[72:75], v[104:107], a[16:31]
    ds_read_b64_tr_b16 a[110:111], v8 offset:29184
    ds_read_b64_tr_b16 a[112:113], v7 offset:25600
    ds_read_b64_tr_b16 a[114:115], v7 offset:26112
    v_mul_f32_dpp v52, v78, v43 row_ror:8 row_mask:0xf bank_mask:0xf
    v_fma_f32 v78, v42, v78, v52
    v_mul_f32_dpp v53, v86, v47 row_ror:8 row_mask:0xf bank_mask:0xf
    v_fma_f32 v86, v46, v86, v53
    v_mul_f32_dpp v54, v94, v51 row_ror:8 row_mask:0xf bank_mask:0xf
    v_fma_f32 v94, v50, v94, v54
    v_mul_f32_dpp v55, v63, v35 row_ror:8 row_mask:0xf bank_mask:0xf
    v_mfma_f32_32x32x16_bf16 a[48:63], a[76:79], v[104:107], a[48:63]
    ds_read_b64_tr_b16 a[116:117], v7 offset:29696
    ds_read_b64_tr_b16 a[118:119], v7 offset:30208
    ds_read_b64_tr_b16 a[120:121], v8 offset:25600
    v_permlane16_swap_b32 v108, v188
    v_fma_f32 v63, v34, v63, v55
    v_mul_f32_dpp v52, v71, v39 row_ror:8 row_mask:0xf bank_mask:0xf
    v_fma_f32 v71, v38, v71, v52
    v_mul_f32_dpp v53, v79, v43 row_ror:8 row_mask:0xf bank_mask:0xf
    v_fma_f32 v79, v42, v79, v53
    v_mul_f32_dpp v54, v87, v47 row_ror:8 row_mask:0xf bank_mask:0xf
    v_mfma_f32_32x32x16_bf16 a[0:15], a[80:83], v[184:187], a[0:15]
    ds_read_b64_tr_b16 a[122:123], v8 offset:26112
    ds_read_b64_tr_b16 a[124:125], v8 offset:29696
    ds_read_b64_tr_b16 a[126:127], v8 offset:30208
    v_permlane16_swap_b32 v109, v189
    buffer_load_dwordx4 v6, s[44:47], s31 offen offset:3072  lds
    v_fma_f32 v87, v46, v87, v54
    v_mul_f32_dpp v55, v95, v51 row_ror:8 row_mask:0xf bank_mask:0xf
    v_fma_f32 v95, v50, v95, v55
    v_fma_f32 v34, v32, v56, v57
    v_fma_f32 v38, v36, v64, v65
    v_fma_f32 v42, v40, v72, v73
    v_fma_f32 v46, v44, v80, v81
    v_mfma_f32_32x32x16_bf16 a[32:47], a[84:87], v[184:187], a[32:47]
    v_permlane16_swap_b32 v110, v190
    v_fma_f32 v50, v48, v88, v89
    v_fmac_f32_dpp v34, v56, v33 row_ror:8 row_mask:0xf bank_mask:0xf
    v_fmac_f32_dpp v38, v64, v37 row_ror:8 row_mask:0xf bank_mask:0xf
    v_fmac_f32_dpp v42, v72, v41 row_ror:8 row_mask:0xf bank_mask:0xf
    v_fmac_f32_dpp v46, v80, v45 row_ror:8 row_mask:0xf bank_mask:0xf
    v_fmac_f32_dpp v50, v88, v49 row_ror:8 row_mask:0xf bank_mask:0xf
    v_mfma_f32_32x32x16_bf16 a[16:31], a[88:91], v[184:187], a[16:31]
    v_permlane16_swap_b32 v111, v191
    v_fma_f32 v35, v32, v34, v58
    v_fma_f32 v39, v36, v38, v66
    v_fma_f32 v43, v40, v42, v74
    v_fma_f32 v47, v44, v46, v82
    v_fma_f32 v51, v48, v50, v90
    v_fmac_f32_dpp v35, v34, v33 row_ror:8 row_mask:0xf bank_mask:0xf
    v_fmac_f32_dpp v39, v38, v37 row_ror:8 row_mask:0xf bank_mask:0xf
    v_mfma_f32_32x32x16_bf16 a[48:63], a[92:95], v[184:187], a[48:63]
    v_fmac_f32_dpp v43, v42, v41 row_ror:8 row_mask:0xf bank_mask:0xf
    v_fmac_f32_dpp v47, v46, v45 row_ror:8 row_mask:0xf bank_mask:0xf
    v_fmac_f32_dpp v51, v50, v49 row_ror:8 row_mask:0xf bank_mask:0xf
    v_fma_f32 v34, v32, v35, v59
    v_fma_f32 v38, v36, v39, v67
    v_fma_f32 v42, v40, v43, v75
    v_fma_f32 v46, v44, v47, v83
    s_waitcnt lgkmcnt(0)
    v_mfma_f32_32x32x16_bf16 a[0:15], a[96:99], v[108:111], a[0:15]
    s_waitcnt vmcnt(12)
    s_barrier
    v_mfma_f32_32x32x16_bf16 a[32:47], a[100:103], v[108:111], a[32:47]
    ds_read_b64_tr_b16 a[64:65], v7 offset:32768
    ds_read_b64_tr_b16 a[66:67], v7 offset:33280
    ds_read_b64_tr_b16 a[68:69], v7 offset:36864
    ds_read_b64_tr_b16 a[70:71], v7 offset:37376
    buffer_store_dword v30, off, s[48:51], s29 sc1
    v_fma_f32 v50, v48, v51, v91
    v_fmac_f32_dpp v34, v35, v33 row_ror:8 row_mask:0xf bank_mask:0xf
    v_fmac_f32_dpp v38, v39, v37 row_ror:8 row_mask:0xf bank_mask:0xf
    v_fmac_f32_dpp v42, v43, v41 row_ror:8 row_mask:0xf bank_mask:0xf
    v_fmac_f32_dpp v46, v47, v45 row_ror:8 row_mask:0xf bank_mask:0xf
    v_fmac_f32_dpp v50, v51, v49 row_ror:8 row_mask:0xf bank_mask:0xf
    v_fma_f32 v35, v32, v34, v60
    v_fma_f32 v39, v36, v38, v68
    v_fma_f32 v43, v40, v42, v76
    v_fma_f32 v47, v44, v46, v84
    v_fma_f32 v51, v48, v50, v92
    v_fmac_f32_dpp v35, v34, v33 row_ror:8 row_mask:0xf bank_mask:0xf
    v_fmac_f32_dpp v39, v38, v37 row_ror:8 row_mask:0xf bank_mask:0xf
    v_mfma_f32_32x32x16_bf16 a[16:31], a[104:107], v[108:111], a[16:31]
    ds_read_b64_tr_b16 a[72:73], v8 offset:32768
    ds_read_b64_tr_b16 a[74:75], v8 offset:33280
    ds_read_b64_tr_b16 a[76:77], v8 offset:36864
    s_add_u32 m0, s93, 16384
    s_add_u32 s4, s16, 196608
    buffer_load_dwordx4 v13, s[44:47], s4 offen offset:0  lds
    v_fmac_f32_dpp v43, v42, v41 row_ror:8 row_mask:0xf bank_mask:0xf
    v_fmac_f32_dpp v47, v46, v45 row_ror:8 row_mask:0xf bank_mask:0xf
    v_fmac_f32_dpp v51, v50, v49 row_ror:8 row_mask:0xf bank_mask:0xf
    v_fma_f32 v34, v32, v35, v61
    v_fma_f32 v38, v36, v39, v69
    v_fma_f32 v42, v40, v43, v77
    v_mfma_f32_32x32x16_bf16 a[48:63], a[108:111], v[108:111], a[48:63]
    ds_read_b64_tr_b16 a[78:79], v8 offset:37376
    ds_read_b64_tr_b16 a[80:81], v7 offset:33792
    ds_read_b64_tr_b16 a[82:83], v7 offset:34304
    v_permlane16_swap_b32 v112, v192
    buffer_load_dwordx4 v14, s[44:47], s4 offen offset:1024  lds
    v_fma_f32 v46, v44, v47, v85
    v_fma_f32 v50, v48, v51, v93
    v_fmac_f32_dpp v34, v35, v33 row_ror:8 row_mask:0xf bank_mask:0xf
    v_fmac_f32_dpp v38, v39, v37 row_ror:8 row_mask:0xf bank_mask:0xf
    v_fmac_f32_dpp v42, v43, v41 row_ror:8 row_mask:0xf bank_mask:0xf
    v_fmac_f32_dpp v46, v47, v45 row_ror:8 row_mask:0xf bank_mask:0xf
    v_fmac_f32_dpp v50, v51, v49 row_ror:8 row_mask:0xf bank_mask:0xf
    v_mfma_f32_32x32x16_bf16 a[0:15], a[112:115], v[188:191], a[0:15]
    ds_read_b64_tr_b16 a[84:85], v7 offset:37888
    ds_read_b64_tr_b16 a[86:87], v7 offset:38400
    ds_read_b64_tr_b16 a[88:89], v8 offset:33792
    v_permlane16_swap_b32 v113, v193
    buffer_load_dwordx4 v15, s[44:47], s4 offen offset:2048  lds
    v_fma_f32 v35, v32, v34, v62
    v_fma_f32 v39, v36, v38, v70
    v_fma_f32 v43, v40, v42, v78
    v_fma_f32 v47, v44, v46, v86
    v_fma_f32 v51, v48, v50, v94
    v_fmac_f32_dpp v35, v34, v33 row_ror:8 row_mask:0xf bank_mask:0xf
    v_mfma_f32_32x32x16_bf16 a[32:47], a[116:119], v[188:191], a[32:47]
    ds_read_b64_tr_b16 a[90:91], v8 offset:34304
    ds_read_b64_tr_b16 a[92:93], v8 offset:37888
    ds_read_b64_tr_b16 a[94:95], v8 offset:38400
    v_permlane16_swap_b32 v114, v194
    buffer_load_dwordx4 v16, s[44:47], s4 offen offset:3072  lds
    v_fmac_f32_dpp v39, v38, v37 row_ror:8 row_mask:0xf bank_mask:0xf
    v_fmac_f32_dpp v43, v42, v41 row_ror:8 row_mask:0xf bank_mask:0xf
    v_fmac_f32_dpp v47, v46, v45 row_ror:8 row_mask:0xf bank_mask:0xf
    v_fmac_f32_dpp v51, v50, v49 row_ror:8 row_mask:0xf bank_mask:0xf
    v_fma_f32 v34, v32, v35, v63
    v_fma_f32 v38, v36, v39, v71
    v_fma_f32 v42, v40, v43, v79
    v_mfma_f32_32x32x16_bf16 a[16:31], a[120:123], v[188:191], a[16:31]
    v_permlane16_swap_b32 v115, v195
    v_fma_f32 v46, v44, v47, v87
    v_fma_f32 v50, v48, v51, v95
    v_fmac_f32_dpp v34, v35, v33 row_ror:8 row_mask:0xf bank_mask:0xf
    v_fmac_f32_dpp v38, v39, v37 row_ror:8 row_mask:0xf bank_mask:0xf
    v_fmac_f32_dpp v42, v43, v41 row_ror:8 row_mask:0xf bank_mask:0xf
    v_fmac_f32_dpp v46, v47, v45 row_ror:8 row_mask:0xf bank_mask:0xf
    v_fmac_f32_dpp v50, v51, v49 row_ror:8 row_mask:0xf bank_mask:0xf
    v_mfma_f32_32x32x16_bf16 a[48:63], a[124:127], v[188:191], a[48:63]
    ds_write_b32 v17, v34 offset:4352
    ds_write_b32 v17, v38 offset:4608
    ds_write_b32 v17, v42 offset:4864
    ds_write_b32 v17, v46 offset:5120
    ds_write_b32 v17, v50 offset:5376
    s_waitcnt lgkmcnt(5)
    v_mfma_f32_32x32x16_bf16 a[0:15], a[64:67], v[112:115], a[0:15]
    ds_read_b64_tr_b16 a[96:97], v7 offset:40960
    ds_read_b64_tr_b16 a[98:99], v7 offset:41472
    ds_read_b64_tr_b16 a[100:101], v7 offset:45056
    ds_read_b64_tr_b16 a[102:103], v7 offset:45568
    v_mfma_f32_32x32x16_bf16 a[32:47], a[68:71], v[112:115], a[32:47]
    ds_read_b64_tr_b16 a[104:105], v8 offset:40960
    ds_read_b64_tr_b16 a[106:107], v8 offset:41472
    ds_read_b64_tr_b16 a[108:109], v8 offset:45056
    v_mfma_f32_32x32x16_bf16 a[16:31], a[72:75], v[112:115], a[16:31]
    ds_read_b64_tr_b16 a[110:111], v8 offset:45568
    ds_read_b64_tr_b16 a[112:113], v7 offset:41984
    ds_read_b64_tr_b16 a[114:115], v7 offset:42496
    v_mfma_f32_32x32x16_bf16 a[48:63], a[76:79], v[112:115], a[48:63]
    ds_read_b64_tr_b16 a[116:117], v7 offset:46080
    ds_read_b64_tr_b16 a[118:119], v7 offset:46592
    ds_read_b64_tr_b16 a[120:121], v8 offset:41984
    v_permlane16_swap_b32 v116, v196
    v_mfma_f32_32x32x16_bf16 a[0:15], a[80:83], v[192:195], a[0:15]
    ds_read_b64_tr_b16 a[122:123], v8 offset:42496
    ds_read_b64_tr_b16 a[124:125], v8 offset:46080
    ds_read_b64_tr_b16 a[126:127], v8 offset:46592
    v_permlane16_swap_b32 v117, v197
    v_mfma_f32_32x32x16_bf16 a[32:47], a[84:87], v[192:195], a[32:47]
    v_permlane16_swap_b32 v118, v198
    ds_read_b128 v[40:43], v20 offset:1280
    ds_read_b128 v[32:35], v18 offset:4352
    ds_read_b128 v[36:39], v18 offset:4480
    s_waitcnt lgkmcnt(1)
    v_fma_f32 v44, v40, v32, v33
    s_waitcnt lgkmcnt(0)
    v_fma_f32 v45, v40, v36, v37
    v_fma_f32 v44, -v41, v36, v44
    v_fma_f32 v45, v41, v32, v45
    v_fma_f32 v46, v40, v44, v34
    v_fma_f32 v47, v40, v45, v38
    v_fma_f32 v46, -v41, v45, v46
    v_fma_f32 v47, v41, v44, v47
    v_fma_f32 v44, v40, v46, v35
    v_fma_f32 v45, v40, v47, v39
    v_fma_f32 v44, -v41, v47, v44
    v_fma_f32 v45, v41, v46, v45
    v_mfma_f32_32x32x16_bf16 a[16:31], a[88:91], v[192:195], a[16:31]
    v_permlane16_swap_b32 v119, v199
    ds_write_b64 v21, v[44:45] offset:1536
    v_mfma_f32_32x32x16_bf16 a[48:63], a[92:95], v[192:195], a[48:63]
    v_mfma_f32_32x32x16_bf16 a[0:15], a[96:99], v[116:119], a[0:15]
    s_waitcnt vmcnt(13) lgkmcnt(0)
    s_barrier
    v_mfma_f32_32x32x16_bf16 a[32:47], a[100:103], v[116:119], a[32:47]
    ds_read_b64_tr_b16 a[64:65], v7 offset:49152
    ds_read_b64_tr_b16 a[66:67], v7 offset:49664
    ds_read_b64_tr_b16 a[68:69], v7 offset:53248
    ds_read_b64_tr_b16 a[70:71], v7 offset:53760
    s_add_u32 m0, s93, 32768
    s_nop 0
    buffer_load_dwordx4 v13, s[44:47], s17 offen offset:0  lds
    v_mfma_f32_32x32x16_bf16 a[16:31], a[104:107], v[116:119], a[16:31]
    ds_read_b64_tr_b16 a[72:73], v8 offset:49152
    ds_read_b64_tr_b16 a[74:75], v8 offset:49664
    ds_read_b64_tr_b16 a[76:77], v8 offset:53248
    buffer_load_dwordx4 v14, s[44:47], s17 offen offset:1024  lds
    v_mfma_f32_32x32x16_bf16 a[48:63], a[108:111], v[116:119], a[48:63]
    ds_read_b64_tr_b16 a[78:79], v8 offset:53760
    ds_read_b64_tr_b16 a[80:81], v7 offset:50176
    ds_read_b64_tr_b16 a[82:83], v7 offset:50688
    v_permlane16_swap_b32 v120, v200
    v_mfma_f32_32x32x16_bf16 a[0:15], a[112:115], v[196:199], a[0:15]
    ds_read_b64_tr_b16 a[84:85], v7 offset:54272
    ds_read_b64_tr_b16 a[86:87], v7 offset:54784
    ds_read_b64_tr_b16 a[88:89], v8 offset:50176
    v_permlane16_swap_b32 v121, v201
    buffer_load_dwordx4 v15, s[44:47], s17 offen offset:2048  lds
    v_mfma_f32_32x32x16_bf16 a[32:47], a[116:119], v[196:199], a[32:47]
    ds_read_b64_tr_b16 a[90:91], v8 offset:50688
    ds_read_b64_tr_b16 a[92:93], v8 offset:54272
    ds_read_b64_tr_b16 a[94:95], v8 offset:54784
    v_permlane16_swap_b32 v122, v202
    ds_read_b128 v[40:43], v20 offset:1280
    ds_read_b64 v[32:33], v21 offset:0
    ds_read_b64 v[34:35], v21 offset:512
    ds_read_b64 v[36:37], v21 offset:1024
    ds_read_b64 v[38:39], v21 offset:1536
    v_mfma_f32_32x32x16_bf16 a[16:31], a[120:123], v[196:199], a[16:31]
    v_permlane16_swap_b32 v123, v203
    buffer_load_dwordx4 v16, s[44:47], s17 offen offset:3072  lds
    v_mfma_f32_32x32x16_bf16 a[48:63], a[124:127], v[196:199], a[48:63]
    s_waitcnt lgkmcnt(5)
    v_mfma_f32_32x32x16_bf16 a[0:15], a[64:67], v[120:123], a[0:15]
    ds_read_b64_tr_b16 a[96:97], v7 offset:57344
    ds_read_b64_tr_b16 a[98:99], v7 offset:57856
    ds_read_b64_tr_b16 a[100:101], v7 offset:61440
    ds_read_b64_tr_b16 a[102:103], v7 offset:61952
    s_waitcnt lgkmcnt(6)
    v_fma_f32 v44, v42, v32, v34
    v_mfma_f32_32x32x16_bf16 a[32:47], a[68:71], v[120:123], a[32:47]
    ds_read_b64_tr_b16 a[104:105], v8 offset:57344
    ds_read_b64_tr_b16 a[106:107], v8 offset:57856
    ds_read_b64_tr_b16 a[108:109], v8 offset:61440
    s_add_u32 m0, s93, 81920
    s_add_u32 s31, s15, s77
    buffer_load_dwordx4 v3, s[44:47], s31 offen offset:0  lds
    v_mfma_f32_32x32x16_bf16 a[16:31], a[72:75], v[120:123], a[16:31]
    ds_read_b64_tr_b16 a[110:111], v8 offset:61952
    ds_read_b64_tr_b16 a[112:113], v7 offset:58368
    ds_read_b64_tr_b16 a[114:115], v7 offset:58880
    v_fma_f32 v45, v42, v33, v35
    v_fma_f32 v44, -v43, v33, v44
    v_mfma_f32_32x32x16_bf16 a[48:63], a[76:79], v[120:123], a[48:63]
    ds_read_b64_tr_b16 a[116:117], v7 offset:62464
    ds_read_b64_tr_b16 a[118:119], v7 offset:62976
    ds_read_b64_tr_b16 a[120:121], v8 offset:58368
    v_permlane16_swap_b32 v124, v204
    v_fma_f32 v45, v43, v32, v45
    v_mfma_f32_32x32x16_bf16 a[0:15], a[80:83], v[200:203], a[0:15]
    ds_read_b64_tr_b16 a[122:123], v8 offset:58880
    ds_read_b64_tr_b16 a[124:125], v8 offset:62464
    ds_read_b64_tr_b16 a[126:127], v8 offset:62976
    v_permlane16_swap_b32 v125, v205
    buffer_load_dwordx4 v4, s[44:47], s31 offen offset:1024  lds
    v_mfma_f32_32x32x16_bf16 a[32:47], a[84:87], v[200:203], a[32:47]
    v_permlane16_swap_b32 v126, v206
    s_waitcnt lgkmcnt(15)
    v_fma_f32 v27, v42, v44, v36
    v_fma_f32 v28, v42, v45, v37
    v_fma_f32 v27, -v43, v45, v27
    v_fma_f32 v28, v43, v44, v28
    v_mfma_f32_32x32x16_bf16 a[16:31], a[88:91], v[200:203], a[16:31]
    v_permlane16_swap_b32 v127, v207
    v_fma_f32 v44, v42, v27, v38
    v_fma_f32 v45, v42, v28, v39
    v_fma_f32 v44, -v43, v28, v44
    v_fma_f32 v45, v43, v27, v45
    v_mfma_f32_32x32x16_bf16 a[48:63], a[92:95], v[200:203], a[48:63]
    v_mov_b32 v46, s69
    v_mov_b32 v47, s69
    s_waitcnt lgkmcnt(0)
    v_mfma_f32_32x32x16_bf16 a[0:15], a[96:99], v[124:127], a[0:15]
    s_waitcnt vmcnt(13)
    s_barrier
    v_mfma_f32_32x32x16_bf16 a[32:47], a[100:103], v[124:127], a[32:47]
    ds_read_b64_tr_b16 a[64:65], v7 offset:0
    ds_read_b64_tr_b16 a[66:67], v7 offset:512
    ds_read_b64_tr_b16 a[68:69], v7 offset:4096
    ds_read_b64_tr_b16 a[70:71], v7 offset:4608
    s_add_u32 m0, s93, 49152
    s_add_u32 s4, s17, 196608
    buffer_load_dwordx4 v13, s[44:47], s4 offen offset:0  lds
    v_mfma_f32_32x32x16_bf16 a[16:31], a[104:107], v[124:127], a[16:31]
    ds_read_b64_tr_b16 a[72:73], v8 offset:0
    ds_read_b64_tr_b16 a[74:75], v8 offset:512
    ds_read_b64_tr_b16 a[76:77], v8 offset:4096
    buffer_load_dwordx4 v14, s[44:47], s4 offen offset:1024  lds
    v_mfma_f32_32x32x16_bf16 a[48:63], a[108:111], v[124:127], a[48:63]
    ds_read_b64_tr_b16 a[78:79], v8 offset:4608
    ds_read_b64_tr_b16 a[80:81], v7 offset:1024
    ds_read_b64_tr_b16 a[82:83], v7 offset:1536
    v_permlane16_swap_b32 v128, v208
    buffer_store_dwordx4 v[44:47], v26, s[48:51], s83 offen sc1
    v_mfma_f32_32x32x16_bf16 a[0:15], a[112:115], v[204:207], a[0:15]
    ds_read_b64_tr_b16 a[84:85], v7 offset:5120
    ds_read_b64_tr_b16 a[86:87], v7 offset:5632
    ds_read_b64_tr_b16 a[88:89], v8 offset:1024
    v_permlane16_swap_b32 v129, v209
    buffer_load_dwordx4 v15, s[44:47], s4 offen offset:2048  lds
    v_mfma_f32_32x32x16_bf16 a[32:47], a[116:119], v[204:207], a[32:47]
    ds_read_b64_tr_b16 a[90:91], v8 offset:1536
    ds_read_b64_tr_b16 a[92:93], v8 offset:5120
    ds_read_b64_tr_b16 a[94:95], v8 offset:5632
    v_permlane16_swap_b32 v130, v210
    v_mfma_f32_32x32x16_bf16 a[16:31], a[120:123], v[204:207], a[16:31]
    v_permlane16_swap_b32 v131, v211
    v_mfma_f32_32x32x16_bf16 a[48:63], a[124:127], v[204:207], a[48:63]
    s_waitcnt lgkmcnt(0)
    v_mfma_f32_32x32x16_bf16 a[0:15], a[64:67], v[128:131], a[0:15]
    ds_read_b64_tr_b16 a[96:97], v7 offset:8192
    ds_read_b64_tr_b16 a[98:99], v7 offset:8704
    ds_read_b64_tr_b16 a[100:101], v7 offset:12288
    ds_read_b64_tr_b16 a[102:103], v7 offset:12800
    v_mfma_f32_32x32x16_bf16 a[32:47], a[68:71], v[128:131], a[32:47]
    ds_read_b64_tr_b16 a[104:105], v8 offset:8192
    ds_read_b64_tr_b16 a[106:107], v8 offset:8704
    ds_read_b64_tr_b16 a[108:109], v8 offset:12288
    buffer_load_dwordx4 v16, s[44:47], s4 offen offset:3072  lds
    v_mfma_f32_32x32x16_bf16 a[16:31], a[72:75], v[128:131], a[16:31]
    ds_read_b64_tr_b16 a[110:111], v8 offset:12800
    ds_read_b64_tr_b16 a[112:113], v7 offset:9216
    ds_read_b64_tr_b16 a[114:115], v7 offset:9728
    s_lshl_b32 s4, s68, 7
    s_add_u32 s4, s4, 16056320
    v_and_b32 v29, 31, v1
    v_lshlrev_b32 v29, 2, v29
    buffer_load_dword v29, v29, s[48:51], s4 offen sc1
    v_mfma_f32_32x32x16_bf16 a[48:63], a[76:79], v[128:131], a[48:63]
    ds_read_b64_tr_b16 a[116:117], v7 offset:13312
    ds_read_b64_tr_b16 a[118:119], v7 offset:13824
    ds_read_b64_tr_b16 a[120:121], v8 offset:9216
    v_permlane16_swap_b32 v132, v212
    s_add_u32 m0, s93, 81920
    s_nop 0
    buffer_load_dwordx4 v5, s[44:47], s31 offen offset:2048  lds
    v_mfma_f32_32x32x16_bf16 a[0:15], a[80:83], v[208:211], a[0:15]
    ds_read_b64_tr_b16 a[122:123], v8 offset:9728
    ds_read_b64_tr_b16 a[124:125], v8 offset:13312
    ds_read_b64_tr_b16 a[126:127], v8 offset:13824
    v_permlane16_swap_b32 v133, v213
    v_mfma_f32_32x32x16_bf16 a[32:47], a[84:87], v[208:211], a[32:47]
    v_permlane16_swap_b32 v134, v214
    v_mfma_f32_32x32x16_bf16 a[16:31], a[88:91], v[208:211], a[16:31]
    v_permlane16_swap_b32 v135, v215
    buffer_load_dwordx4 v6, s[44:47], s31 offen offset:3072  lds
    v_mfma_f32_32x32x16_bf16 a[48:63], a[92:95], v[208:211], a[48:63]
    s_waitcnt lgkmcnt(0)
    v_mfma_f32_32x32x16_bf16 a[0:15], a[96:99], v[132:135], a[0:15]
    s_waitcnt vmcnt(14)
    s_barrier
    v_mfma_f32_32x32x16_bf16 a[32:47], a[100:103], v[132:135], a[32:47]
    ds_read_b64_tr_b16 a[64:65], v7 offset:16384
    ds_read_b64_tr_b16 a[66:67], v7 offset:16896
    ds_read_b64_tr_b16 a[68:69], v7 offset:20480
    ds_read_b64_tr_b16 a[70:71], v7 offset:20992
    s_add_u32 m0, s93, 0
    s_nop 0
    buffer_load_dwordx4 v13, s[44:47], s28 offen offset:0  lds
    v_mfma_f32_32x32x16_bf16 a[16:31], a[104:107], v[132:135], a[16:31]
    ds_read_b64_tr_b16 a[72:73], v8 offset:16384
    ds_read_b64_tr_b16 a[74:75], v8 offset:16896
    ds_read_b64_tr_b16 a[76:77], v8 offset:20480
    buffer_load_dwordx4 v14, s[44:47], s28 offen offset:1024  lds
    v_mfma_f32_32x32x16_bf16 a[48:63], a[108:111], v[132:135], a[48:63]
    ds_read_b64_tr_b16 a[78:79], v8 offset:20992
    ds_read_b64_tr_b16 a[80:81], v7 offset:17408
    ds_read_b64_tr_b16 a[82:83], v7 offset:17920
    v_permlane16_swap_b32 v136, v216
    buffer_load_dwordx4 v15, s[44:47], s28 offen offset:2048  lds
    v_mfma_f32_32x32x16_bf16 a[0:15], a[112:115], v[212:215], a[0:15]
    ds_read_b64_tr_b16 a[84:85], v7 offset:21504
    ds_read_b64_tr_b16 a[86:87], v7 offset:22016
    ds_read_b64_tr_b16 a[88:89], v8 offset:17408
    v_permlane16_swap_b32 v137, v217
    buffer_load_dwordx4 v16, s[44:47], s28 offen offset:3072  lds
    v_mfma_f32_32x32x16_bf16 a[32:47], a[116:119], v[212:215], a[32:47]
    ds_read_b64_tr_b16 a[90:91], v8 offset:17920
    ds_read_b64_tr_b16 a[92:93], v8 offset:21504
    ds_read_b64_tr_b16 a[94:95], v8 offset:22016
    v_permlane16_swap_b32 v138, v218
    s_waitcnt vmcnt(6)
    v_cmp_ne_u32 vcc, s69, v29
    s_cbranch_vccz L_ok2
    s_mov_b32 s94, 262144
L_rt2:
    s_sleep 1
    s_lshl_b32 s4, s68, 7
    s_add_u32 s4, s4, 16056320
    v_and_b32 v29, 31, v1
    v_lshlrev_b32 v29, 2, v29
    buffer_load_dword v29, v29, s[48:51], s4 offen sc1
    s_waitcnt vmcnt(0)
    s_nop 1
    v_cmp_ne_u32 vcc, s69, v29
    s_cbranch_vccz L_ok2
    s_sub_u32 s94, s94, 1
    s_cmp_lg_u32 s94, 0
    s_cbranch_scc1 L_rt2
    s_nop 7
L_ok2:
    v_mfma_f32_32x32x16_bf16 a[16:31], a[120:123], v[212:215], a[16:31]
    v_permlane16_swap_b32 v139, v219
    s_add_u32 s11, s12, 0
    buffer_load_dwordx4 a[196:199], v2, s[48:51], s11 offen offset:0 sc1
    v_mfma_f32_32x32x16_bf16 a[48:63], a[124:127], v[212:215], a[48:63]
    buffer_load_dwordx4 a[200:203], v2, s[48:51], s11 offen offset:1024 sc1
    s_waitcnt lgkmcnt(0)
    v_mfma_f32_32x32x16_bf16 a[0:15], a[64:67], v[136:139], a[0:15]
    ds_read_b64_tr_b16 a[96:97], v7 offset:24576
    ds_read_b64_tr_b16 a[98:99], v7 offset:25088
    ds_read_b64_tr_b16 a[100:101], v7 offset:28672
    ds_read_b64_tr_b16 a[102:103], v7 offset:29184
    v_mfma_f32_32x32x16_bf16 a[32:47], a[68:71], v[136:139], a[32:47]
    ds_read_b64_tr_b16 a[104:105], v8 offset:24576
    ds_read_b64_tr_b16 a[106:107], v8 offset:25088
    ds_read_b64_tr_b16 a[108:109], v8 offset:28672
    buffer_load_dwordx4 a[204:207], v2, s[48:51], s11 offen offset:2048 sc1
    v_mfma_f32_32x32x16_bf16 a[16:31], a[72:75], v[136:139], a[16:31]
    ds_read_b64_tr_b16 a[110:111], v8 offset:29184
    ds_read_b64_tr_b16 a[112:113], v7 offset:25600
    ds_read_b64_tr_b16 a[114:115], v7 offset:26112
    buffer_load_dwordx4 a[208:211], v2, s[48:51], s11 offen offset:3072 sc1
    v_mfma_f32_32x32x16_bf16 a[48:63], a[76:79], v[136:139], a[48:63]
    ds_read_b64_tr_b16 a[116:117], v7 offset:29696
    ds_read_b64_tr_b16 a[118:119], v7 offset:30208
    ds_read_b64_tr_b16 a[120:121], v8 offset:25600
    v_permlane16_swap_b32 v140, v220
    v_mfma_f32_32x32x16_bf16 a[0:15], a[80:83], v[216:219], a[0:15]
    ds_read_b64_tr_b16 a[122:123], v8 offset:26112
    ds_read_b64_tr_b16 a[124:125], v8 offset:29696
    ds_read_b64_tr_b16 a[126:127], v8 offset:30208
    v_permlane16_swap_b32 v141, v221
    buffer_load_dwordx4 a[212:215], v12, s[48:51], s11 offen offset:0 sc1
    v_mfma_f32_32x32x16_bf16 a[32:47], a[84:87], v[216:219], a[32:47]
    v_permlane16_swap_b32 v142, v222
    v_mfma_f32_32x32x16_bf16 a[16:31], a[88:91], v[216:219], a[16:31]
    v_permlane16_swap_b32 v143, v223
    v_mfma_f32_32x32x16_bf16 a[48:63], a[92:95], v[216:219], a[48:63]
    s_add_u32 s11, s12, 5120
    buffer_load_dwordx4 a[216:219], v2, s[48:51], s11 offen offset:0 sc1
    s_waitcnt lgkmcnt(0)
    v_mfma_f32_32x32x16_bf16 a[0:15], a[96:99], v[140:143], a[0:15]
    s_barrier
    v_mfma_f32_32x32x16_bf16 a[32:47], a[100:103], v[140:143], a[32:47]
    ds_read_b64_tr_b16 a[64:65], v7 offset:32768
    ds_read_b64_tr_b16 a[66:67], v7 offset:33280
    ds_read_b64_tr_b16 a[68:69], v7 offset:36864
    ds_read_b64_tr_b16 a[70:71], v7 offset:37376
    buffer_load_dwordx4 a[180:183], v26, s[48:51], s84 offen sc1
    v_mfma_f32_32x32x16_bf16 a[16:31], a[104:107], v[140:143], a[16:31]
    ds_read_b64_tr_b16 a[72:73], v8 offset:32768
    ds_read_b64_tr_b16 a[74:75], v8 offset:33280
    ds_read_b64_tr_b16 a[76:77], v8 offset:36864
    v_mfma_f32_32x32x16_bf16 a[48:63], a[108:111], v[140:143], a[48:63]
    ds_read_b64_tr_b16 a[78:79], v8 offset:37376
    ds_read_b64_tr_b16 a[80:81], v7 offset:33792
    ds_read_b64_tr_b16 a[82:83], v7 offset:34304
    v_permlane16_swap_b32 v144, v224
    buffer_load_dwordx4 a[184:187], v26, s[48:51], s85 offen sc1
    v_mfma_f32_32x32x16_bf16 a[0:15], a[112:115], v[220:223], a[0:15]
    ds_read_b64_tr_b16 a[84:85], v7 offset:37888
    ds_read_b64_tr_b16 a[86:87], v7 offset:38400
    ds_read_b64_tr_b16 a[88:89], v8 offset:33792
    v_permlane16_swap_b32 v145, v225
    v_mfma_f32_32x32x16_bf16 a[32:47], a[116:119], v[220:223], a[32:47]
    ds_read_b64_tr_b16 a[90:91], v8 offset:34304
    ds_read_b64_tr_b16 a[92:93], v8 offset:37888
    ds_read_b64_tr_b16 a[94:95], v8 offset:38400
    v_permlane16_swap_b32 v146, v226
    buffer_load_dwordx4 a[188:191], v26, s[48:51], s86 offen sc1
    v_mfma_f32_32x32x16_bf16 a[16:31], a[120:123], v[220:223], a[16:31]
    v_permlane16_swap_b32 v147, v227
    buffer_load_dwordx4 a[192:195], v26, s[48:51], s87 offen sc1
    v_mfma_f32_32x32x16_bf16 a[48:63], a[124:127], v[220:223], a[48:63]
    s_add_u32 m0, s93, 16384
    s_add_u32 s4, s28, 196608
    buffer_load_dwordx4 v13, s[44:47], s4 offen offset:0  lds
    s_waitcnt lgkmcnt(0)
    v_mfma_f32_32x32x16_bf16 a[0:15], a[64:67], v[144:147], a[0:15]
    ds_read_b64_tr_b16 a[96:97], v7 offset:40960
    ds_read_b64_tr_b16 a[98:99], v7 offset:41472
    ds_read_b64_tr_b16 a[100:101], v7 offset:45056
    ds_read_b64_tr_b16 a[102:103], v7 offset:45568
    v_mfma_f32_32x32x16_bf16 a[32:47], a[68:71], v[144:147], a[32:47]
    ds_read_b64_tr_b16 a[104:105], v8 offset:40960
    ds_read_b64_tr_b16 a[106:107], v8 offset:41472
    ds_read_b64_tr_b16 a[108:109], v8 offset:45056
    buffer_load_dwordx4 v14, s[44:47], s4 offen offset:1024  lds
    v_mfma_f32_32x32x16_bf16 a[16:31], a[72:75], v[144:147], a[16:31]
    ds_read_b64_tr_b16 a[110:111], v8 offset:45568
    ds_read_b64_tr_b16 a[112:113], v7 offset:41984
    ds_read_b64_tr_b16 a[114:115], v7 offset:42496
    buffer_load_dwordx4 v15, s[44:47], s4 offen offset:2048  lds
    v_mfma_f32_32x32x16_bf16 a[48:63], a[76:79], v[144:147], a[48:63]
    ds_read_b64_tr_b16 a[116:117], v7 offset:46080
    ds_read_b64_tr_b16 a[118:119], v7 offset:46592
    ds_read_b64_tr_b16 a[120:121], v8 offset:41984
    v_permlane16_swap_b32 v148, v228
    v_mfma_f32_32x32x16_bf16 a[0:15], a[80:83], v[224:227], a[0:15]
    ds_read_b64_tr_b16 a[122:123], v8 offset:42496
    ds_read_b64_tr_b16 a[124:125], v8 offset:46080
    ds_read_b64_tr_b16 a[126:127], v8 offset:46592
    v_permlane16_swap_b32 v149, v229
    buffer_load_dwordx4 v16, s[44:47], s4 offen offset:3072  lds
    v_mfma_f32_32x32x16_bf16 a[32:47], a[84:87], v[224:227], a[32:47]
    v_permlane16_swap_b32 v150, v230
    v_mfma_f32_32x32x16_bf16 a[16:31], a[88:91], v[224:227], a[16:31]
    v_permlane16_swap_b32 v151, v231
    buffer_load_dwordx4 a[220:223], v2, s[48:51], s11 offen offset:1024 sc1
    v_mfma_f32_32x32x16_bf16 a[48:63], a[92:95], v[224:227], a[48:63]
    buffer_load_dwordx4 a[224:227], v2, s[48:51], s11 offen offset:2048 sc1
    s_waitcnt lgkmcnt(0)
    v_mfma_f32_32x32x16_bf16 a[0:15], a[96:99], v[148:151], a[0:15]
    s_barrier
    v_mfma_f32_32x32x16_bf16 a[32:47], a[100:103], v[148:151], a[32:47]
    ds_read_b64_tr_b16 a[64:65], v7 offset:49152
    ds_read_b64_tr_b16 a[66:67], v7 offset:49664
    ds_read_b64_tr_b16 a[68:69], v7 offset:53248
    ds_read_b64_tr_b16 a[70:71], v7 offset:53760
    s_add_u32 m0, s93, 32768
    s_add_u32 s31, s16, s77
    buffer_load_dwordx4 v3, s[44:47], s31 offen offset:0  lds
    v_mfma_f32_32x32x16_bf16 a[16:31], a[104:107], v[148:151], a[16:31]
    ds_read_b64_tr_b16 a[72:73], v8 offset:49152
    ds_read_b64_tr_b16 a[74:75], v8 offset:49664
    ds_read_b64_tr_b16 a[76:77], v8 offset:53248
    v_mfma_f32_32x32x16_bf16 a[48:63], a[108:111], v[148:151], a[48:63]
    ds_read_b64_tr_b16 a[78:79], v8 offset:53760
    ds_read_b64_tr_b16 a[80:81], v7 offset:50176
    ds_read_b64_tr_b16 a[82:83], v7 offset:50688
    v_permlane16_swap_b32 v152, v232
    v_mfma_f32_32x32x16_bf16 a[0:15], a[112:115], v[228:231], a[0:15]
    ds_read_b64_tr_b16 a[84:85], v7 offset:54272
    ds_read_b64_tr_b16 a[86:87], v7 offset:54784
    ds_read_b64_tr_b16 a[88:89], v8 offset:50176
    v_permlane16_swap_b32 v153, v233
    buffer_load_dwordx4 v4, s[44:47], s31 offen offset:1024  lds
    v_mfma_f32_32x32x16_bf16 a[32:47], a[116:119], v[228:231], a[32:47]
    ds_read_b64_tr_b16 a[90:91], v8 offset:50688
    ds_read_b64_tr_b16 a[92:93], v8 offset:54272
    ds_read_b64_tr_b16 a[94:95], v8 offset:54784
    v_permlane16_swap_b32 v154, v234
    v_mfma_f32_32x32x16_bf16 a[16:31], a[120:123], v[228:231], a[16:31]
    v_permlane16_swap_b32 v155, v235
    v_mfma_f32_32x32x16_bf16 a[48:63], a[124:127], v[228:231], a[48:63]
    s_waitcnt lgkmcnt(0)
    v_mfma_f32_32x32x16_bf16 a[0:15], a[64:67], v[152:155], a[0:15]
    ds_read_b64_tr_b16 a[96:97], v7 offset:57344
    ds_read_b64_tr_b16 a[98:99], v7 offset:57856
    ds_read_b64_tr_b16 a[100:101], v7 offset:61440
    ds_read_b64_tr_b16 a[102:103], v7 offset:61952
    v_mfma_f32_32x32x16_bf16 a[32:47], a[68:71], v[152:155], a[32:47]
    ds_read_b64_tr_b16 a[104:105], v8 offset:57344
    ds_read_b64_tr_b16 a[106:107], v8 offset:57856
    ds_read_b64_tr_b16 a[108:109], v8 offset:61440
    buffer_load_dwordx4 v5, s[44:47], s31 offen offset:2048  lds
    v_mfma_f32_32x32x16_bf16 a[16:31], a[72:75], v[152:155], a[16:31]
    ds_read_b64_tr_b16 a[110:111], v8 offset:61952
    ds_read_b64_tr_b16 a[112:113], v7 offset:58368
    ds_read_b64_tr_b16 a[114:115], v7 offset:58880
    v_mfma_f32_32x32x16_bf16 a[48:63], a[76:79], v[152:155], a[48:63]
    ds_read_b64_tr_b16 a[116:117], v7 offset:62464
    ds_read_b64_tr_b16 a[118:119], v7 offset:62976
    ds_read_b64_tr_b16 a[120:121], v8 offset:58368
    v_permlane16_swap_b32 v156, v236
    buffer_load_dwordx4 v6, s[44:47], s31 offen offset:3072  lds
    v_mfma_f32_32x32x16_bf16 a[0:15], a[80:83], v[232:235], a[0:15]
    ds_read_b64_tr_b16 a[122:123], v8 offset:58880
    ds_read_b64_tr_b16 a[124:125], v8 offset:62464
    ds_read_b64_tr_b16 a[126:127], v8 offset:62976
    v_permlane16_swap_b32 v157, v237
    v_mfma_f32_32x32x16_bf16 a[32:47], a[84:87], v[232:235], a[32:47]
    v_permlane16_swap_b32 v158, v238
    v_mfma_f32_32x32x16_bf16 a[16:31], a[88:91], v[232:235], a[16:31]
    v_permlane16_swap_b32 v159, v239
    v_mfma_f32_32x32x16_bf16 a[48:63], a[92:95], v[232:235], a[48:63]
    s_waitcnt lgkmcnt(0)
    v_mfma_f32_32x32x16_bf16 a[0:15], a[96:99], v[156:159], a[0:15]
    s_waitcnt vmcnt(20)
    s_barrier
    v_mfma_f32_32x32x16_bf16 a[32:47], a[100:103], v[156:159], a[32:47]
    ds_read_b64_tr_b16 a[64:65], v7 offset:0
    ds_read_b64_tr_b16 a[66:67], v7 offset:512
    ds_read_b64_tr_b16 a[68:69], v7 offset:4096
    ds_read_b64_tr_b16 a[70:71], v7 offset:4608
    s_add_u32 m0, s93, 49152
    s_add_u32 s31, s17, s77
    buffer_load_dwordx4 v3, s[44:47], s31 offen offset:0  lds
    ds_read_b128 v[40:43], v20 offset:2304
    ds_read_b64 v[44:45], v20 offset:3328
    s_cmp_lt_u32 s84, 1073741824
    s_cselect_b32 s72, s69, 0
    s_waitcnt vmcnt(14)
    v_accvgpr_read_b32 v34, a182
    v_xor_b32 v34, s72, v34
    s_cmp_lt_u32 s85, 1073741824
    s_cselect_b32 s72, s69, 0
    s_waitcnt vmcnt(13)
    v_accvgpr_read_b32 v32, a186
    v_xor_b32 v32, s72, v32
    v_or_b32 v34, v34, v32
    s_cmp_lt_u32 s86, 1073741824
    s_cselect_b32 s72, s69, 0
    s_waitcnt vmcnt(12)
    v_accvgpr_read_b32 v32, a190
    v_xor_b32 v32, s72, v32
    v_or_b32 v34, v34, v32
    s_cmp_lt_u32 s87, 1073741824
    s_cselect_b32 s72, s69, 0
    v_mfma_f32_32x32x16_bf16 a[16:31], a[104:107], v[156:159], a[16:31]
    ds_read_b64_tr_b16 a[72:73], v8 offset:0
    ds_read_b64_tr_b16 a[74:75], v8 offset:512
    ds_read_b64_tr_b16 a[76:77], v8 offset:4096
    buffer_load_dwordx4 v4, s[44:47], s31 offen offset:1024  lds
    s_waitcnt vmcnt(12)
    v_accvgpr_read_b32 v32, a194
    v_xor_b32 v32, s72, v32
    v_or_b32 v34, v34, v32
    v_cmp_ne_u32 vcc, 0, v34
    s_cbranch_vccz L_ok3
    s_mov_b32 s94, 262144
L_rt3:
    s_sleep 1
    buffer_load_dwordx4 a[180:183], v26, s[48:51], s84 offen sc1
    buffer_load_dwordx4 a[184:187], v26, s[48:51], s85 offen sc1
    buffer_load_dwordx4 a[188:191], v26, s[48:51], s86 offen sc1
    buffer_load_dwordx4 a[192:195], v26, s[48:51], s87 offen sc1
    s_waitcnt vmcnt(0)
    s_nop 1
    s_cmp_lt_u32 s84, 1073741824
    s_cselect_b32 s72, s69, 0
    v_accvgpr_read_b32 v34, a182
    v_xor_b32 v34, s72, v34
    s_cmp_lt_u32 s85, 1073741824
    s_cselect_b32 s72, s69, 0
    v_accvgpr_read_b32 v32, a186
    v_xor_b32 v32, s72, v32
    v_or_b32 v34, v34, v32
    s_cmp_lt_u32 s86, 1073741824
    s_cselect_b32 s72, s69, 0
    v_accvgpr_read_b32 v32, a190
    v_xor_b32 v32, s72, v32
    v_or_b32 v34, v34, v32
    s_cmp_lt_u32 s87, 1073741824
    s_cselect_b32 s72, s69, 0
    v_accvgpr_read_b32 v32, a194
    v_xor_b32 v32, s72, v32
    v_or_b32 v34, v34, v32
    v_cmp_ne_u32 vcc, 0, v34
    s_cbranch_vccz L_ok3
    s_sub_u32 s94, s94, 1
    s_cmp_lg_u32 s94, 0
    s_cbranch_scc1 L_rt3
    s_nop 7
L_ok3:
    v_mfma_f32_32x32x16_bf16 a[48:63], a[108:111], v[156:159], a[48:63]
    ds_read_b64_tr_b16 a[78:79], v8 offset:4608
    ds_read_b64_tr_b16 a[80:81], v7 offset:1024
    ds_read_b64_tr_b16 a[82:83], v7 offset:1536
    v_permlane16_swap_b32 v160, v240
    v_accvgpr_read_b32 v32, a180
    v_mfma_f32_32x32x16_bf16 a[0:15], a[112:115], v[236:239], a[0:15]
    ds_read_b64_tr_b16 a[84:85], v7 offset:5120
    ds_read_b64_tr_b16 a[86:87], v7 offset:5632
    ds_read_b64_tr_b16 a[88:89], v8 offset:1024
    v_permlane16_swap_b32 v161, v241
    v_accvgpr_read_b32 v33, a181
    v_mfma_f32_32x32x16_bf16 a[32:47], a[116:119], v[236:239], a[32:47]
    ds_read_b64_tr_b16 a[90:91], v8 offset:1536
    ds_read_b64_tr_b16 a[92:93], v8 offset:5120
    ds_read_b64_tr_b16 a[94:95], v8 offset:5632
    v_permlane16_swap_b32 v162, v242
    v_accvgpr_read_b32 v34, a184
    v_mfma_f32_32x32x16_bf16 a[16:31], a[120:123], v[236:239], a[16:31]
    v_permlane16_swap_b32 v163, v243
    v_accvgpr_read_b32 v35, a185
    v_accvgpr_read_b32 v36, a188
    v_accvgpr_read_b32 v37, a189
    v_accvgpr_read_b32 v38, a192
    v_mfma_f32_32x32x16_bf16 a[48:63], a[124:127], v[236:239], a[48:63]
    v_accvgpr_read_b32 v39, a193
    s_waitcnt lgkmcnt(13)
    v_fma_f32 v46, v42, v32, v34
    v_fma_f32 v47, v42, v33, v35
    v_fma_f32 v46, -v43, v33, v46
    v_fma_f32 v47, v43, v32, v47
    s_waitcnt lgkmcnt(0)
    v_mfma_f32_32x32x16_bf16 a[0:15], a[64:67], v[160:163], a[0:15]
    ds_read_b64_tr_b16 a[96:97], v7 offset:8192
    ds_read_b64_tr_b16 a[98:99], v7 offset:8704
    ds_read_b64_tr_b16 a[100:101], v7 offset:12288
    ds_read_b64_tr_b16 a[102:103], v7 offset:12800
    v_fma_f32 v48, v42, v46, v36
    v_mfma_f32_32x32x16_bf16 a[32:47], a[68:71], v[160:163], a[32:47]
    ds_read_b64_tr_b16 a[104:105], v8 offset:8192
    ds_read_b64_tr_b16 a[106:107], v8 offset:8704
    ds_read_b64_tr_b16 a[108:109], v8 offset:12288
    v_fma_f32 v49, v42, v47, v37
    v_fma_f32 v48, -v43, v47, v48
    v_mfma_f32_32x32x16_bf16 a[16:31], a[72:75], v[160:163], a[16:31]
    ds_read_b64_tr_b16 a[110:111], v8 offset:12800
    ds_read_b64_tr_b16 a[112:113], v7 offset:9216
    ds_read_b64_tr_b16 a[114:115], v7 offset:9728
    v_fma_f32 v49, v43, v46, v49
    v_fma_f32 v46, v42, v48, v38
    v_mfma_f32_32x32x16_bf16 a[48:63], a[76:79], v[160:163], a[48:63]
    ds_read_b64_tr_b16 a[116:117], v7 offset:13312
    ds_read_b64_tr_b16 a[118:119], v7 offset:13824
    ds_read_b64_tr_b16 a[120:121], v8 offset:9216
    v_permlane16_swap_b32 v164, v244
    v_fma_f32 v47, v42, v49, v39
    v_mfma_f32_32x32x16_bf16 a[0:15], a[80:83], v[240:243], a[0:15]
    ds_read_b64_tr_b16 a[122:123], v8 offset:9728
    ds_read_b64_tr_b16 a[124:125], v8 offset:13312
    ds_read_b64_tr_b16 a[126:127], v8 offset:13824
    v_permlane16_swap_b32 v165, v245
    v_fma_f32 v46, -v43, v49, v46
    v_fma_f32 v47, v43, v48, v47
    v_mul_f32 v50, v47, v45
    v_mfma_f32_32x32x16_bf16 a[32:47], a[84:87], v[240:243], a[32:47]
    v_permlane16_swap_b32 v166, v246
    s_add_u32 m0, s93, 49152
    s_nop 0
    buffer_load_dwordx4 v5, s[44:47], s31 offen offset:2048  lds
    v_mul_f32 v49, v47, v44
    v_fma_f32 v48, v46, v44, -v50
    v_fmac_f32 v49, v46, v45
    s_lshl_b32 s72, s64, 3
    v_add_u32 v50, s72, v22
    v_mfma_f32_32x32x16_bf16 a[16:31], a[88:91], v[240:243], a[16:31]
    v_permlane16_swap_b32 v167, v247
    ds_write_b64 v50, v[48:49]
    v_mfma_f32_32x32x16_bf16 a[48:63], a[92:95], v[240:243], a[48:63]
    s_waitcnt lgkmcnt(1)
    v_mfma_f32_32x32x16_bf16 a[0:15], a[96:99], v[164:167], a[0:15]
    s_waitcnt vmcnt(9) lgkmcnt(0)
    s_barrier
    v_mfma_f32_32x32x16_bf16 a[32:47], a[100:103], v[164:167], a[32:47]
    ds_read_b64_tr_b16 a[64:65], v7 offset:16384
    ds_read_b64_tr_b16 a[66:67], v7 offset:16896
    ds_read_b64_tr_b16 a[68:69], v7 offset:20480
    ds_read_b64_tr_b16 a[70:71], v7 offset:20992
    buffer_load_dwordx4 v6, s[44:47], s31 offen offset:3072  lds
    ds_read_b128 v[32:35], v22
    v_mfma_f32_32x32x16_bf16 a[16:31], a[104:107], v[164:167], a[16:31]
    ds_read_b64_tr_b16 a[72:73], v8 offset:16384
    ds_read_b64_tr_b16 a[74:75], v8 offset:16896
    ds_read_b64_tr_b16 a[76:77], v8 offset:20480
    v_mfma_f32_32x32x16_bf16 a[48:63], a[108:111], v[164:167], a[48:63]
    ds_read_b64_tr_b16 a[78:79], v8 offset:20992
    ds_read_b64_tr_b16 a[80:81], v7 offset:17408
    ds_read_b64_tr_b16 a[82:83], v7 offset:17920
    v_permlane16_swap_b32 v168, v248
    v_mfma_f32_32x32x16_bf16 a[0:15], a[112:115], v[244:247], a[0:15]
    ds_read_b64_tr_b16 a[84:85], v7 offset:21504
    ds_read_b64_tr_b16 a[86:87], v7 offset:22016
    ds_read_b64_tr_b16 a[88:89], v8 offset:17408
    v_permlane16_swap_b32 v169, v249
    s_add_u32 m0, s93, 0
    s_add_u32 s31, s28, s77
    buffer_load_dwordx4 v3, s[44:47], s31 offen offset:0  lds
    v_mfma_f32_32x32x16_bf16 a[32:47], a[116:119], v[244:247], a[32:47]
    ds_read_b64_tr_b16 a[90:91], v8 offset:17920
    ds_read_b64_tr_b16 a[92:93], v8 offset:21504
    ds_read_b64_tr_b16 a[94:95], v8 offset:22016
    v_permlane16_swap_b32 v170, v250
    ds_read_b128 v[36:39], v22 offset:16
    ds_read_b64 v[52:53], v20 offset:2304
    ds_read_b128 v[48:51], v20 offset:1280
    ds_read_b128 v[40:43], v18 offset:4352
    ds_read_b128 v[44:47], v18 offset:4480
    s_waitcnt lgkmcnt(15)
    v_add_f32 v32, v32, v34
    v_add_f32 v33, v33, v35
    s_waitcnt lgkmcnt(4)
    v_add_f32 v36, v36, v38
    v_add_f32 v37, v37, v39
    v_add_f32 v32, v32, v36
    v_mfma_f32_32x32x16_bf16 a[16:31], a[120:123], v[244:247], a[16:31]
    v_permlane16_swap_b32 v171, v251
    buffer_load_dwordx4 v4, s[44:47], s31 offen offset:1024  lds
    v_add_f32 v33, v33, v37
    s_waitcnt lgkmcnt(3)
    v_fma_f32 v34, v52, v32, v27
    v_fma_f32 v35, v52, v33, v28
    v_mfma_f32_32x32x16_bf16 a[48:63], a[124:127], v[244:247], a[48:63]
    v_fma_f32 v34, -v53, v33, v34
    v_fma_f32 v35, v53, v32, v35
    v_mov_b32 v36, v34
    v_mov_b32 v52, v35
    s_waitcnt lgkmcnt(1)
    v_fma_f32 v37, v48, v36, v40
    v_mfma_f32_32x32x16_bf16 a[0:15], a[64:67], v[168:171], a[0:15]
    ds_read_b64_tr_b16 a[96:97], v7 offset:24576
    ds_read_b64_tr_b16 a[98:99], v7 offset:25088
    ds_read_b64_tr_b16 a[100:101], v7 offset:28672
    ds_read_b64_tr_b16 a[102:103], v7 offset:29184
    s_waitcnt lgkmcnt(4)
    v_fma_f32 v53, v48, v52, v44
    v_mfma_f32_32x32x16_bf16 a[32:47], a[68:71], v[168:171], a[32:47]
    ds_read_b64_tr_b16 a[104:105], v8 offset:24576
    ds_read_b64_tr_b16 a[106:107], v8 offset:25088
    ds_read_b64_tr_b16 a[108:109], v8 offset:28672
    buffer_load_dwordx4 v5, s[44:47], s31 offen offset:2048  lds
    v_fma_f32 v37, -v49, v52, v37
    v_fma_f32 v53, v49, v36, v53
    v_mfma_f32_32x32x16_bf16 a[16:31], a[72:75], v[168:171], a[16:31]
    ds_read_b64_tr_b16 a[110:111], v8 offset:29184
    ds_read_b64_tr_b16 a[112:113], v7 offset:25600
    ds_read_b64_tr_b16 a[114:115], v7 offset:26112
    v_fma_f32 v38, v48, v37, v41
    v_fma_f32 v54, v48, v53, v45
    v_fma_f32 v38, -v49, v53, v38
    v_mfma_f32_32x32x16_bf16 a[48:63], a[76:79], v[168:171], a[48:63]
    ds_read_b64_tr_b16 a[116:117], v7 offset:29696
    ds_read_b64_tr_b16 a[118:119], v7 offset:30208
    ds_read_b64_tr_b16 a[120:121], v8 offset:25600
    v_permlane16_swap_b32 v172, v252
    v_fma_f32 v54, v49, v37, v54
    v_fma_f32 v39, v48, v38, v42
    v_fma_f32 v55, v48, v54, v46
    v_mfma_f32_32x32x16_bf16 a[0:15], a[80:83], v[248:251], a[0:15]
    ds_read_b64_tr_b16 a[122:123], v8 offset:26112
    ds_read_b64_tr_b16 a[124:125], v8 offset:29696
    ds_read_b64_tr_b16 a[126:127], v8 offset:30208
    v_permlane16_swap_b32 v173, v253
    v_fma_f32 v39, -v49, v54, v39
    v_fma_f32 v55, v49, v38, v55
    v_mfma_f32_32x32x16_bf16 a[32:47], a[84:87], v[248:251], a[32:47]
    v_permlane16_swap_b32 v174, v254
    ds_write_b128 v18, v[36:39] offset:4352
    ds_write_b128 v18, v[52:55] offset:4480
    v_mfma_f32_32x32x16_bf16 a[16:31], a[88:91], v[248:251], a[16:31]
    v_permlane16_swap_b32 v175, v255
    buffer_load_dwordx4 v6, s[44:47], s31 offen offset:3072  lds
    v_mfma_f32_32x32x16_bf16 a[48:63], a[92:95], v[248:251], a[48:63]
    s_waitcnt lgkmcnt(2)
    v_mfma_f32_32x32x16_bf16 a[0:15], a[96:99], v[172:175], a[0:15]
    s_waitcnt lgkmcnt(0)
    s_barrier
    v_mfma_f32_32x32x16_bf16 a[32:47], a[100:103], v[172:175], a[32:47]
    ds_read_b64_tr_b16 a[64:65], v11 offset:0
    ds_read_b64_tr_b16 a[66:67], v11 offset:256
    ds_read_b64_tr_b16 a[68:69], v11 offset:4096
    ds_read_b64_tr_b16 a[70:71], v11 offset:4352
    buffer_load_dwordx4 a[228:231], v2, s[48:51], s11 offen offset:3072 sc1
    v_mfma_f32_32x32x16_bf16 a[16:31], a[104:107], v[172:175], a[16:31]
    ds_read_b64_tr_b16 a[72:73], v11 offset:512
    ds_read_b64_tr_b16 a[74:75], v11 offset:768
    ds_read_b64_tr_b16 a[76:77], v11 offset:4608
    buffer_load_dwordx4 a[232:235], v12, s[48:51], s11 offen offset:0 sc1
    v_mfma_f32_32x32x16_bf16 a[48:63], a[108:111], v[172:175], a[48:63]
    ds_read_b64_tr_b16 a[78:79], v11 offset:4864
    ds_read_b64_tr_b16 a[80:81], v11 offset:2048
    ds_read_b64_tr_b16 a[82:83], v11 offset:2304
    v_mfma_f32_32x32x16_bf16 a[0:15], a[112:115], v[252:255], a[0:15]
    ds_read_b64_tr_b16 a[84:85], v11 offset:6144
    ds_read_b64_tr_b16 a[86:87], v11 offset:6400
    ds_read_b64_tr_b16 a[88:89], v11 offset:2560
    s_add_u32 s11, s12, 20480
    buffer_load_dwordx4 a[236:239], v2, s[48:51], s11 offen offset:0 sc1
    v_mfma_f32_32x32x16_bf16 a[32:47], a[116:119], v[252:255], a[32:47]
    ds_read_b64_tr_b16 a[90:91], v11 offset:2816
    ds_read_b64_tr_b16 a[92:93], v11 offset:6656
    ds_read_b64_tr_b16 a[94:95], v11 offset:6912
    v_mfma_f32_32x32x16_bf16 a[16:31], a[120:123], v[252:255], a[16:31]
    v_mfma_f32_32x32x16_bf16 a[48:63], a[124:127], v[252:255], a[48:63]
    buffer_load_dwordx4 a[240:243], v2, s[48:51], s11 offen offset:1024 sc1
    s_waitcnt lgkmcnt(0)
    v_mfma_f32_32x32x16_bf16 a[128:143], a[64:67], v[96:99], 0
    ds_read_b64_tr_b16 a[96:97], v11 offset:8192
    ds_read_b64_tr_b16 a[98:99], v11 offset:8448
    ds_read_b64_tr_b16 a[100:101], v11 offset:12288
    ds_read_b64_tr_b16 a[102:103], v11 offset:12544
    v_accvgpr_read_b32 v32, a0
    v_accvgpr_read_b32 v40, a32
    v_accvgpr_read_b32 v33, a1
    v_accvgpr_read_b32 v41, a33
    v_accvgpr_read_b32 v34, a2
    v_accvgpr_read_b32 v42, a34
    v_accvgpr_read_b32 v35, a3
    v_accvgpr_read_b32 v43, a35
    v_accvgpr_read_b32 v36, a4
    v_accvgpr_read_b32 v44, a36
    v_accvgpr_read_b32 v37, a5
    v_accvgpr_read_b32 v45, a37
    v_mfma_f32_32x32x16_bf16 a[144:159], a[68:71], v[96:99], 0
    ds_read_b64_tr_b16 a[104:105], v11 offset:8704
    ds_read_b64_tr_b16 a[106:107], v11 offset:8960
    ds_read_b64_tr_b16 a[108:109], v11 offset:12800
    buffer_load_dwordx4 a[244:247], v2, s[48:51], s11 offen offset:2048 sc1
    v_accvgpr_read_b32 v38, a6
    v_accvgpr_read_b32 v46, a38
    v_accvgpr_read_b32 v39, a7
    v_accvgpr_read_b32 v47, a39
    v_mul_f32 v48, 0xbfb8aa3b, v32
    v_mul_f32 v49, 0xbfb8aa3b, v33
    v_mul_f32 v50, 0xbfb8aa3b, v34
    v_mfma_f32_32x32x16_bf16 a[128:143], a[72:75], v[176:179], a[128:143]
    ds_read_b64_tr_b16 a[110:111], v11 offset:13056
    ds_read_b64_tr_b16 a[112:113], v11 offset:10240
    ds_read_b64_tr_b16 a[114:115], v11 offset:10496
    buffer_load_dwordx4 a[248:251], v2, s[48:51], s11 offen offset:3072 sc1
    v_mul_f32 v51, 0xbfb8aa3b, v35
    v_mul_f32 v52, 0xbfb8aa3b, v36
    v_mul_f32 v53, 0xbfb8aa3b, v37
    v_mul_f32 v54, 0xbfb8aa3b, v38
    v_mul_f32 v55, 0xbfb8aa3b, v39
    v_mfma_f32_32x32x16_bf16 a[144:159], a[76:79], v[176:179], a[144:159]
    ds_read_b64_tr_b16 a[116:117], v11 offset:14336
    ds_read_b64_tr_b16 a[118:119], v11 offset:14592
    ds_read_b64_tr_b16 a[120:121], v11 offset:10752
    buffer_load_dwordx4 a[252:255], v12, s[48:51], s11 offen offset:0 sc1
    v_exp_f32 v48, v48
    v_mul_f32 v32, v32, v40
    v_exp_f32 v49, v49
    v_mul_f32 v33, v33, v41
    v_exp_f32 v50, v50
    v_mfma_f32_32x32x16_bf16 a[128:143], a[80:83], v[100:103], a[128:143]
    ds_read_b64_tr_b16 a[122:123], v11 offset:11008
    ds_read_b64_tr_b16 a[124:125], v11 offset:14848
    ds_read_b64_tr_b16 a[126:127], v11 offset:15104
    s_add_u32 s11, s12, 25600
    buffer_load_dwordx4 a[160:163], v2, s[48:51], s11 offen offset:0 sc1
    v_mul_f32 v34, v34, v42
    v_exp_f32 v51, v51
    v_mul_f32 v35, v35, v43
    v_exp_f32 v52, v52
    v_mfma_f32_32x32x16_bf16 a[144:159], a[84:87], v[100:103], a[144:159]
    v_mul_f32 v36, v36, v44
    v_exp_f32 v53, v53
    v_mul_f32 v37, v37, v45
    v_exp_f32 v54, v54
    v_mul_f32 v38, v38, v46
    v_mfma_f32_32x32x16_bf16 a[128:143], a[88:91], v[180:183], a[128:143]
    buffer_load_dwordx4 a[164:167], v2, s[48:51], s11 offen offset:1024 sc1
    v_exp_f32 v55, v55
    v_mul_f32 v39, v39, v47
    v_add_f32 v48, 1.0, v48
    v_add_f32 v49, 1.0, v49
    v_add_f32 v50, 1.0, v50
    v_mfma_f32_32x32x16_bf16 a[144:159], a[92:95], v[180:183], a[144:159]
    v_add_f32 v51, 1.0, v51
    v_add_f32 v52, 1.0, v52
    v_add_f32 v53, 1.0, v53
    v_add_f32 v54, 1.0, v54
    v_add_f32 v55, 1.0, v55
    s_waitcnt lgkmcnt(0)
    v_mfma_f32_32x32x16_bf16 a[128:143], a[96:99], v[104:107], a[128:143]
    s_barrier
    v_mfma_f32_32x32x16_bf16 a[144:159], a[100:103], v[104:107], a[144:159]
    ds_read_b64_tr_b16 a[64:65], v11 offset:16384
    ds_read_b64_tr_b16 a[66:67], v11 offset:16640
    ds_read_b64_tr_b16 a[68:69], v11 offset:20480
    ds_read_b64_tr_b16 a[70:71], v11 offset:20736
    buffer_load_dwordx4 a[168:171], v2, s[48:51], s11 offen offset:2048 sc1
    v_rcp_f32 v48, v48
    v_rcp_f32 v49, v49
    v_rcp_f32 v50, v50
    v_rcp_f32 v51, v51
    v_rcp_f32 v52, v52
    v_rcp_f32 v53, v53
    v_rcp_f32 v54, v54
    v_mfma_f32_32x32x16_bf16 a[128:143], a[104:107], v[184:187], a[128:143]
    ds_read_b64_tr_b16 a[72:73], v11 offset:16896
    ds_read_b64_tr_b16 a[74:75], v11 offset:17152
    ds_read_b64_tr_b16 a[76:77], v11 offset:20992
    buffer_load_dwordx4 a[172:175], v2, s[48:51], s11 offen offset:3072 sc1
    v_rcp_f32 v55, v55
    v_mul_f32 v32, v32, v48
    v_mul_f32 v33, v33, v49
    v_mul_f32 v34, v34, v50
    v_mul_f32 v35, v35, v51
    v_mul_f32 v36, v36, v52
    v_mfma_f32_32x32x16_bf16 a[144:159], a[108:111], v[184:187], a[144:159]
    ds_read_b64_tr_b16 a[78:79], v11 offset:21248
    ds_read_b64_tr_b16 a[80:81], v11 offset:18432
    ds_read_b64_tr_b16 a[82:83], v11 offset:18688
    buffer_load_dwordx4 a[176:179], v12, s[48:51], s11 offen offset:0 sc1
    v_mul_f32 v37, v37, v53
    v_mul_f32 v38, v38, v54
    v_mul_f32 v39, v39, v55
    v_cvt_pk_bf16_f32 v40, v32, v33
    v_cvt_pk_bf16_f32 v41, v34, v35
    v_cvt_pk_bf16_f32 v42, v36, v37
    v_mfma_f32_32x32x16_bf16 a[128:143], a[112:115], v[108:111], a[128:143]
    ds_read_b64_tr_b16 a[84:85], v11 offset:22528
    ds_read_b64_tr_b16 a[86:87], v11 offset:22784
    ds_read_b64_tr_b16 a[88:89], v11 offset:18944
    v_cvt_pk_bf16_f32 v43, v38, v39
    s_add_u32 s72, s81, 0
    buffer_store_dwordx4 v[40:43], v10, s[48:51], s72 offen offset:0 sc1
    v_accvgpr_read_b32 v32, a8
    v_mfma_f32_32x32x16_bf16 a[144:159], a[116:119], v[108:111], a[144:159]
    ds_read_b64_tr_b16 a[90:91], v11 offset:19200
    ds_read_b64_tr_b16 a[92:93], v11 offset:23040
    ds_read_b64_tr_b16 a[94:95], v11 offset:23296
    v_accvgpr_read_b32 v40, a40
    v_accvgpr_read_b32 v33, a9
    v_accvgpr_read_b32 v41, a41
    v_accvgpr_read_b32 v34, a10
    v_accvgpr_read_b32 v42, a42
    v_accvgpr_read_b32 v35, a11
    v_mfma_f32_32x32x16_bf16 a[128:143], a[120:123], v[188:191], a[128:143]
    v_accvgpr_read_b32 v43, a43
    v_accvgpr_read_b32 v36, a12
    v_accvgpr_read_b32 v44, a44
    v_accvgpr_read_b32 v37, a13
    v_accvgpr_read_b32 v45, a45
    v_accvgpr_read_b32 v38, a14
    v_mfma_f32_32x32x16_bf16 a[144:159], a[124:127], v[188:191], a[144:159]
    v_accvgpr_read_b32 v46, a46
    v_accvgpr_read_b32 v39, a15
    v_accvgpr_read_b32 v47, a47
    v_mul_f32 v48, 0xbfb8aa3b, v32
    v_mul_f32 v49, 0xbfb8aa3b, v33
    v_mul_f32 v50, 0xbfb8aa3b, v34
    v_mul_f32 v51, 0xbfb8aa3b, v35
    s_waitcnt lgkmcnt(0)
    v_mfma_f32_32x32x16_bf16 a[128:143], a[64:67], v[112:115], a[128:143]
    ds_read_b64_tr_b16 a[96:97], v11 offset:24576
    ds_read_b64_tr_b16 a[98:99], v11 offset:24832
    ds_read_b64_tr_b16 a[100:101], v11 offset:28672
    ds_read_b64_tr_b16 a[102:103], v11 offset:28928
    v_mul_f32 v52, 0xbfb8aa3b, v36
    v_mul_f32 v53, 0xbfb8aa3b, v37
    v_mul_f32 v54, 0xbfb8aa3b, v38
    v_mul_f32 v55, 0xbfb8aa3b, v39
    v_exp_f32 v48, v48
    v_mfma_f32_32x32x16_bf16 a[144:159], a[68:71], v[112:115], a[144:159]
    ds_read_b64_tr_b16 a[104:105], v11 offset:25088
    ds_read_b64_tr_b16 a[106:107], v11 offset:25344
    ds_read_b64_tr_b16 a[108:109], v11 offset:29184
    s_add_u32 s11, s12, 30720
    buffer_load_dwordx4 v[96:99], v2, s[48:51], s11 offen offset:0 sc1
    v_mul_f32 v32, v32, v40
    v_exp_f32 v49, v49
    v_mul_f32 v33, v33, v41
    v_exp_f32 v50, v50
    v_mul_f32 v34, v34, v42
    v_mfma_f32_32x32x16_bf16 a[128:143], a[72:75], v[192:195], a[128:143]
    ds_read_b64_tr_b16 a[110:111], v11 offset:29440
    ds_read_b64_tr_b16 a[112:113], v11 offset:26624
    ds_read_b64_tr_b16 a[114:115], v11 offset:26880
    buffer_load_dwordx4 v[100:103], v2, s[48:51], s11 offen offset:1024 sc1
    v_exp_f32 v51, v51
    v_mul_f32 v35, v35, v43
    v_exp_f32 v52, v52
    v_mul_f32 v36, v36, v44
    v_mfma_f32_32x32x16_bf16 a[144:159], a[76:79], v[192:195], a[144:159]
    ds_read_b64_tr_b16 a[116:117], v11 offset:30720
    ds_read_b64_tr_b16 a[118:119], v11 offset:30976
    ds_read_b64_tr_b16 a[120:121], v11 offset:27136
    buffer_load_dwordx4 v[176:179], v2, s[48:51], s11 offen offset:2048 sc1
    v_exp_f32 v53, v53
    v_mul_f32 v37, v37, v45
    v_exp_f32 v54, v54
    v_mul_f32 v38, v38, v46
    v_mfma_f32_32x32x16_bf16 a[128:143], a[80:83], v[116:119], a[128:143]
    ds_read_b64_tr_b16 a[122:123], v11 offset:27392
    ds_read_b64_tr_b16 a[124:125], v11 offset:31232
    ds_read_b64_tr_b16 a[126:127], v11 offset:31488
    buffer_load_dwordx4 v[180:183], v2, s[48:51], s11 offen offset:3072 sc1
    v_exp_f32 v55, v55
    v_mul_f32 v39, v39, v47
    v_add_f32 v48, 1.0, v48
    v_add_f32 v49, 1.0, v49
    v_add_f32 v50, 1.0, v50
    v_add_f32 v51, 1.0, v51
    v_mfma_f32_32x32x16_bf16 a[144:159], a[84:87], v[116:119], a[144:159]
    v_add_f32 v52, 1.0, v52
    v_add_f32 v53, 1.0, v53
    v_add_f32 v54, 1.0, v54
    v_add_f32 v55, 1.0, v55
    v_rcp_f32 v48, v48
    v_mfma_f32_32x32x16_bf16 a[128:143], a[88:91], v[196:199], a[128:143]
    v_rcp_f32 v49, v49
    v_rcp_f32 v50, v50
    v_rcp_f32 v51, v51
    v_mfma_f32_32x32x16_bf16 a[144:159], a[92:95], v[196:199], a[144:159]
    buffer_load_dwordx4 v[104:107], v12, s[48:51], s11 offen offset:0 sc1
    v_rcp_f32 v52, v52
    v_rcp_f32 v53, v53
    v_rcp_f32 v54, v54
    s_waitcnt lgkmcnt(0)
    v_mfma_f32_32x32x16_bf16 a[128:143], a[96:99], v[120:123], a[128:143]
    s_waitcnt vmcnt(26)
    s_barrier
    v_mfma_f32_32x32x16_bf16 a[144:159], a[100:103], v[120:123], a[144:159]
    ds_read_b64_tr_b16 a[64:65], v9 offset:32768
    ds_read_b64_tr_b16 a[66:67], v9 offset:33024
    ds_read_b64_tr_b16 a[68:69], v9 offset:36864
    ds_read_b64_tr_b16 a[70:71], v9 offset:37120
    s_add_u32 s11, s12, 35840
    buffer_load_dwordx4 v[108:111], v2, s[48:51], s11 offen offset:0 sc1
    v_rcp_f32 v55, v55
    v_mul_f32 v32, v32, v48
    v_mul_f32 v33, v33, v49
    v_mul_f32 v34, v34, v50
    v_mul_f32 v35, v35, v51
    v_mul_f32 v36, v36, v52
    v_mul_f32 v37, v37, v53
    v_mul_f32 v38, v38, v54
    v_mul_f32 v39, v39, v55
    v_cvt_pk_bf16_f32 v44, v32, v33
    v_cvt_pk_bf16_f32 v45, v34, v35
    v_cvt_pk_bf16_f32 v46, v36, v37
    v_cvt_pk_bf16_f32 v47, v38, v39
    v_mfma_f32_32x32x16_bf16 a[128:143], a[104:107], v[200:203], a[128:143]
    ds_read_b64_tr_b16 a[72:73], v9 offset:33280
    ds_read_b64_tr_b16 a[74:75], v9 offset:33536
    ds_read_b64_tr_b16 a[76:77], v9 offset:37376
    buffer_load_dwordx4 v[184:187], v2, s[48:51], s11 offen offset:1024 sc1
    buffer_store_dwordx4 v[44:47], v10, s[48:51], s72 offen offset:512 sc1
    v_accvgpr_read_b32 v32, a16
    v_accvgpr_read_b32 v40, a48
    v_accvgpr_read_b32 v33, a17
    v_mfma_f32_32x32x16_bf16 a[144:159], a[108:111], v[200:203], a[144:159]
    ds_read_b64_tr_b16 a[78:79], v9 offset:37632
    ds_read_b64_tr_b16 a[80:81], v9 offset:34816
    ds_read_b64_tr_b16 a[82:83], v9 offset:35072
    buffer_load_dwordx4 v[188:191], v2, s[48:51], s11 offen offset:2048 sc1
    v_accvgpr_read_b32 v41, a49
    v_accvgpr_read_b32 v34, a18
    v_accvgpr_read_b32 v42, a50
    v_accvgpr_read_b32 v35, a19
    v_accvgpr_read_b32 v43, a51
    v_accvgpr_read_b32 v36, a20
    v_mfma_f32_32x32x16_bf16 a[128:143], a[112:115], v[124:127], a[128:143]
    ds_read_b64_tr_b16 a[84:85], v9 offset:38912
    ds_read_b64_tr_b16 a[86:87], v9 offset:39168
    ds_read_b64_tr_b16 a[88:89], v9 offset:35328
    v_accvgpr_read_b32 v44, a52
    v_accvgpr_read_b32 v37, a21
    v_accvgpr_read_b32 v45, a53
    v_accvgpr_read_b32 v38, a22
    v_accvgpr_read_b32 v46, a54
    v_accvgpr_read_b32 v39, a23
    v_accvgpr_read_b32 v47, a55
    v_mfma_f32_32x32x16_bf16 a[144:159], a[116:119], v[124:127], a[144:159]
    ds_read_b64_tr_b16 a[90:91], v9 offset:35584
    ds_read_b64_tr_b16 a[92:93], v9 offset:39424
    ds_read_b64_tr_b16 a[94:95], v9 offset:39680
    buffer_load_dwordx4 v[112:115], v2, s[48:51], s11 offen offset:3072 sc1
    v_mul_f32 v48, 0xbfb8aa3b, v32
    v_mul_f32 v49, 0xbfb8aa3b, v33
    v_mul_f32 v50, 0xbfb8aa3b, v34
    v_mul_f32 v51, 0xbfb8aa3b, v35
    v_mul_f32 v52, 0xbfb8aa3b, v36
    v_mul_f32 v53, 0xbfb8aa3b, v37
    v_mfma_f32_32x32x16_bf16 a[128:143], a[120:123], v[204:207], a[128:143]
    v_mul_f32 v54, 0xbfb8aa3b, v38
    v_mul_f32 v55, 0xbfb8aa3b, v39
    v_exp_f32 v48, v48
    v_mul_f32 v32, v32, v40
    v_mfma_f32_32x32x16_bf16 a[144:159], a[124:127], v[204:207], a[144:159]
    buffer_load_dwordx4 v[116:119], v12, s[48:51], s11 offen offset:0 sc1
    v_exp_f32 v49, v49
    v_mul_f32 v33, v33, v41
    v_exp_f32 v50, v50
    v_mul_f32 v34, v34, v42
    v_exp_f32 v51, v51
    s_waitcnt lgkmcnt(0)
    v_mfma_f32_32x32x16_bf16 a[128:143], a[64:67], v[128:131], a[128:143]
    ds_read_b64_tr_b16 a[96:97], v9 offset:40960
    ds_read_b64_tr_b16 a[98:99], v9 offset:41216
    ds_read_b64_tr_b16 a[100:101], v9 offset:45056
    ds_read_b64_tr_b16 a[102:103], v9 offset:45312
    v_mul_f32 v35, v35, v43
    v_exp_f32 v52, v52
    v_mul_f32 v36, v36, v44
    v_exp_f32 v53, v53
    v_mfma_f32_32x32x16_bf16 a[144:159], a[68:71], v[128:131], a[144:159]
    ds_read_b64_tr_b16 a[104:105], v9 offset:41472
    ds_read_b64_tr_b16 a[106:107], v9 offset:41728
    ds_read_b64_tr_b16 a[108:109], v9 offset:45568
    s_add_u32 s11, s12, 51200
    buffer_load_dwordx4 v[192:195], v2, s[48:51], s11 offen offset:0 sc1
    v_mul_f32 v37, v37, v45
    v_exp_f32 v54, v54
    v_mul_f32 v38, v38, v46
    v_exp_f32 v55, v55
    v_mul_f32 v39, v39, v47
    v_mfma_f32_32x32x16_bf16 a[128:143], a[72:75], v[208:211], a[128:143]
    ds_read_b64_tr_b16 a[110:111], v9 offset:45824
    ds_read_b64_tr_b16 a[112:113], v9 offset:43008
    ds_read_b64_tr_b16 a[114:115], v9 offset:43264
    buffer_load_dwordx4 v[196:199], v2, s[48:51], s11 offen offset:1024 sc1
    v_add_f32 v48, 1.0, v48
    v_add_f32 v49, 1.0, v49
    v_add_f32 v50, 1.0, v50
    v_add_f32 v51, 1.0, v51
    v_add_f32 v52, 1.0, v52
    v_add_f32 v53, 1.0, v53
    v_mfma_f32_32x32x16_bf16 a[144:159], a[76:79], v[208:211], a[144:159]
    ds_read_b64_tr_b16 a[116:117], v9 offset:47104
    ds_read_b64_tr_b16 a[118:119], v9 offset:47360
    ds_read_b64_tr_b16 a[120:121], v9 offset:43520
    buffer_load_dwordx4 v[120:123], v2, s[48:51], s11 offen offset:2048 sc1
    v_add_f32 v54, 1.0, v54
    v_add_f32 v55, 1.0, v55
    v_rcp_f32 v48, v48
    v_rcp_f32 v49, v49
    v_mfma_f32_32x32x16_bf16 a[128:143], a[80:83], v[132:135], a[128:143]
    ds_read_b64_tr_b16 a[122:123], v9 offset:43776
    ds_read_b64_tr_b16 a[124:125], v9 offset:47616
    ds_read_b64_tr_b16 a[126:127], v9 offset:47872
    v_rcp_f32 v50, v50
    v_rcp_f32 v51, v51
    v_rcp_f32 v52, v52
    v_mfma_f32_32x32x16_bf16 a[144:159], a[84:87], v[132:135], a[144:159]
    buffer_load_dwordx4 v[124:127], v2, s[48:51], s11 offen offset:3072 sc1
    v_rcp_f32 v53, v53
    v_rcp_f32 v54, v54
    v_rcp_f32 v55, v55
    v_mul_f32 v32, v32, v48
    v_mul_f32 v33, v33, v49
    v_mfma_f32_32x32x16_bf16 a[128:143], a[88:91], v[212:215], a[128:143]
    v_mul_f32 v34, v34, v50
    v_mul_f32 v35, v35, v51
    v_mul_f32 v36, v36, v52
    v_mul_f32 v37, v37, v53
    v_mul_f32 v38, v38, v54
    v_mul_f32 v39, v39, v55
    v_mfma_f32_32x32x16_bf16 a[144:159], a[92:95], v[212:215], a[144:159]
    buffer_load_dwordx4 v[200:203], v12, s[48:51], s11 offen offset:0 sc1
    v_cvt_pk_bf16_f32 v40, v32, v33
    v_cvt_pk_bf16_f32 v41, v34, v35
    v_cvt_pk_bf16_f32 v42, v36, v37
    v_cvt_pk_bf16_f32 v43, v38, v39
    s_add_u32 s72, s81, 4096
    s_waitcnt lgkmcnt(0)
    v_mfma_f32_32x32x16_bf16 a[128:143], a[96:99], v[136:139], a[128:143]
    s_waitcnt vmcnt(33)
    s_barrier
    v_mfma_f32_32x32x16_bf16 a[144:159], a[100:103], v[136:139], a[144:159]
    ds_read_b64_tr_b16 a[64:65], v9 offset:49152
    ds_read_b64_tr_b16 a[66:67], v9 offset:49408
    ds_read_b64_tr_b16 a[68:69], v9 offset:53248
    ds_read_b64_tr_b16 a[70:71], v9 offset:53504
    s_add_u32 s11, s12, 56320
    buffer_load_dwordx4 v[204:207], v2, s[48:51], s11 offen offset:0 sc1
    buffer_store_dwordx4 v[40:43], v10, s[48:51], s72 offen offset:0 sc1
    v_accvgpr_read_b32 v32, a24
    s_nop 0
    v_accvgpr_read_b32 v40, a56
    v_accvgpr_read_b32 v33, a25
    v_accvgpr_read_b32 v41, a57
    v_accvgpr_read_b32 v34, a26
    v_accvgpr_read_b32 v42, a58
    v_accvgpr_read_b32 v35, a27
    v_accvgpr_read_b32 v43, a59
    v_accvgpr_read_b32 v36, a28
    v_accvgpr_read_b32 v44, a60
    v_mfma_f32_32x32x16_bf16 a[128:143], a[104:107], v[216:219], a[128:143]
    ds_read_b64_tr_b16 a[72:73], v9 offset:49664
    ds_read_b64_tr_b16 a[74:75], v9 offset:49920
    ds_read_b64_tr_b16 a[76:77], v9 offset:53760
    buffer_load_dwordx4 v[128:131], v2, s[48:51], s11 offen offset:1024 sc1
    v_accvgpr_read_b32 v37, a29
    v_accvgpr_read_b32 v45, a61
    v_accvgpr_read_b32 v38, a30
    v_accvgpr_read_b32 v46, a62
    v_accvgpr_read_b32 v39, a31
    v_accvgpr_read_b32 v47, a63
    v_mul_f32 v48, 0xbfb8aa3b, v32
    v_mfma_f32_32x32x16_bf16 a[144:159], a[108:111], v[216:219], a[144:159]
    ds_read_b64_tr_b16 a[78:79], v9 offset:54016
    ds_read_b64_tr_b16 a[80:81], v9 offset:51200
    ds_read_b64_tr_b16 a[82:83], v9 offset:51456
    v_mul_f32 v49, 0xbfb8aa3b, v33
    v_mul_f32 v50, 0xbfb8aa3b, v34
    v_mul_f32 v51, 0xbfb8aa3b, v35
    v_mul_f32 v52, 0xbfb8aa3b, v36
    v_mul_f32 v53, 0xbfb8aa3b, v37
    v_mul_f32 v54, 0xbfb8aa3b, v38
    v_mfma_f32_32x32x16_bf16 a[128:143], a[112:115], v[140:143], a[128:143]
    ds_read_b64_tr_b16 a[84:85], v9 offset:55296
    ds_read_b64_tr_b16 a[86:87], v9 offset:55552
    ds_read_b64_tr_b16 a[88:89], v9 offset:51712
    buffer_load_dwordx4 v[132:135], v2, s[48:51], s11 offen offset:2048 sc1
    v_mul_f32 v55, 0xbfb8aa3b, v39
    v_exp_f32 v48, v48
    v_mul_f32 v32, v32, v40
    v_exp_f32 v49, v49
    v_mul_f32 v33, v33, v41
    v_mfma_f32_32x32x16_bf16 a[144:159], a[116:119], v[140:143], a[144:159]
    ds_read_b64_tr_b16 a[90:91], v9 offset:51968
    ds_read_b64_tr_b16 a[92:93], v9 offset:55808
    ds_read_b64_tr_b16 a[94:95], v9 offset:56064
    buffer_load_dwordx4 v[208:211], v2, s[48:51], s11 offen offset:3072 sc1
    v_exp_f32 v50, v50
    v_mul_f32 v34, v34, v42
    v_exp_f32 v51, v51
    v_mul_f32 v35, v35, v43
    v_mfma_f32_32x32x16_bf16 a[128:143], a[120:123], v[220:223], a[128:143]
    v_exp_f32 v52, v52
    v_mul_f32 v36, v36, v44
    v_exp_f32 v53, v53
    v_mul_f32 v37, v37, v45
    v_mfma_f32_32x32x16_bf16 a[144:159], a[124:127], v[220:223], a[144:159]
    v_exp_f32 v54, v54
    v_mul_f32 v38, v38, v46
    v_exp_f32 v55, v55
    v_mul_f32 v39, v39, v47
    v_add_f32 v48, 1.0, v48
    s_waitcnt lgkmcnt(0)
    v_mfma_f32_32x32x16_bf16 a[128:143], a[64:67], v[144:147], a[128:143]
    ds_read_b64_tr_b16 a[96:97], v9 offset:57344
    ds_read_b64_tr_b16 a[98:99], v9 offset:57600
    ds_read_b64_tr_b16 a[100:101], v9 offset:61440
    ds_read_b64_tr_b16 a[102:103], v9 offset:61696
    v_add_f32 v49, 1.0, v49
    v_add_f32 v50, 1.0, v50
    v_add_f32 v51, 1.0, v51
    v_add_f32 v52, 1.0, v52
    v_add_f32 v53, 1.0, v53
    v_add_f32 v54, 1.0, v54
    v_mfma_f32_32x32x16_bf16 a[144:159], a[68:71], v[144:147], a[144:159]
    ds_read_b64_tr_b16 a[104:105], v9 offset:57856
    ds_read_b64_tr_b16 a[106:107], v9 offset:58112
    ds_read_b64_tr_b16 a[108:109], v9 offset:61952
    buffer_load_dwordx4 v[212:215], v12, s[48:51], s11 offen offset:0 sc1
    v_add_f32 v55, 1.0, v55
    v_rcp_f32 v48, v48
    v_rcp_f32 v49, v49
    v_rcp_f32 v50, v50
    v_mfma_f32_32x32x16_bf16 a[128:143], a[72:75], v[224:227], a[128:143]
    ds_read_b64_tr_b16 a[110:111], v9 offset:62208
    ds_read_b64_tr_b16 a[112:113], v9 offset:59392
    ds_read_b64_tr_b16 a[114:115], v9 offset:59648
    v_rcp_f32 v51, v51
    v_rcp_f32 v52, v52
    v_rcp_f32 v53, v53
    v_mfma_f32_32x32x16_bf16 a[144:159], a[76:79], v[224:227], a[144:159]
    ds_read_b64_tr_b16 a[116:117], v9 offset:63488
    ds_read_b64_tr_b16 a[118:119], v9 offset:63744
    ds_read_b64_tr_b16 a[120:121], v9 offset:59904
    v_rcp_f32 v54, v54
    v_rcp_f32 v55, v55
    v_mul_f32 v32, v32, v48
    v_mul_f32 v33, v33, v49
    v_mul_f32 v34, v34, v50
    v_mfma_f32_32x32x16_bf16 a[128:143], a[80:83], v[148:151], a[128:143]
    ds_read_b64_tr_b16 a[122:123], v9 offset:60160
    ds_read_b64_tr_b16 a[124:125], v9 offset:64000
    ds_read_b64_tr_b16 a[126:127], v9 offset:64256
    v_mul_f32 v35, v35, v51
    v_mul_f32 v36, v36, v52
    v_mul_f32 v37, v37, v53
    v_mul_f32 v38, v38, v54
    v_mul_f32 v39, v39, v55
    v_cvt_pk_bf16_f32 v44, v32, v33
    v_mfma_f32_32x32x16_bf16 a[144:159], a[84:87], v[148:151], a[144:159]
    v_cvt_pk_bf16_f32 v45, v34, v35
    v_cvt_pk_bf16_f32 v46, v36, v37
    v_cvt_pk_bf16_f32 v47, v38, v39
    buffer_store_dwordx4 v[44:47], v10, s[48:51], s72 offen offset:512 sc1
    v_mfma_f32_32x32x16_bf16 a[128:143], a[88:91], v[228:231], a[128:143]
    v_mfma_f32_32x32x16_bf16 a[144:159], a[92:95], v[228:231], a[144:159]
    s_waitcnt lgkmcnt(0)
    v_mfma_f32_32x32x16_bf16 a[128:143], a[96:99], v[152:155], a[128:143]
    s_waitcnt vmcnt(36)
    s_barrier
    v_mfma_f32_32x32x16_bf16 a[144:159], a[100:103], v[152:155], a[144:159]
    ds_read_b64_tr_b16 a[64:65], v9 offset:0
    ds_read_b64_tr_b16 a[66:67], v9 offset:256
    ds_read_b64_tr_b16 a[68:69], v9 offset:4096
    ds_read_b64_tr_b16 a[70:71], v9 offset:4352
    s_add_u32 s4, s64, 0
    s_and_b32 s4, s4, 3
    v_lshl_add_u32 v3, s4, 10, v2
    s_add_u32 s4, s64, 1
    s_and_b32 s4, s4, 3
    v_lshl_add_u32 v4, s4, 10, v2
    s_add_u32 s4, s64, 2
    s_and_b32 s4, s4, 3
    v_lshl_add_u32 v5, s4, 10, v2
    s_add_u32 s4, s64, 3
    s_and_b32 s4, s4, 3
    v_lshl_add_u32 v6, s4, 10, v2
    v_mfma_f32_32x32x16_bf16 a[128:143], a[104:107], v[232:235], a[128:143]
    ds_read_b64_tr_b16 a[72:73], v9 offset:512
    ds_read_b64_tr_b16 a[74:75], v9 offset:768
    ds_read_b64_tr_b16 a[76:77], v9 offset:4608
    s_add_u32 s11, s12, 10240
    buffer_load_dwordx4 v[136:139], v2, s[48:51], s11 offen offset:0 sc1
    v_mfma_f32_32x32x16_bf16 a[144:159], a[108:111], v[232:235], a[144:159]
    ds_read_b64_tr_b16 a[78:79], v9 offset:4864
    ds_read_b64_tr_b16 a[80:81], v9 offset:2048
    ds_read_b64_tr_b16 a[82:83], v9 offset:2304
    buffer_load_dwordx4 v[140:143], v2, s[48:51], s11 offen offset:1024 sc1
    v_mfma_f32_32x32x16_bf16 a[128:143], a[112:115], v[156:159], a[128:143]
    ds_read_b64_tr_b16 a[84:85], v9 offset:6144
    ds_read_b64_tr_b16 a[86:87], v9 offset:6400
    ds_read_b64_tr_b16 a[88:89], v9 offset:2560
    v_mfma_f32_32x32x16_bf16 a[144:159], a[116:119], v[156:159], a[144:159]
    ds_read_b64_tr_b16 a[90:91], v9 offset:2816
    ds_read_b64_tr_b16 a[92:93], v9 offset:6656
    ds_read_b64_tr_b16 a[94:95], v9 offset:6912
    buffer_load_dwordx4 v[216:219], v2, s[48:51], s11 offen offset:2048 sc1
    v_mfma_f32_32x32x16_bf16 a[128:143], a[120:123], v[236:239], a[128:143]
    v_mfma_f32_32x32x16_bf16 a[144:159], a[124:127], v[236:239], a[144:159]
    buffer_load_dwordx4 v[220:223], v2, s[48:51], s11 offen offset:3072 sc1
    s_waitcnt lgkmcnt(0)
    v_mfma_f32_32x32x16_bf16 a[128:143], a[64:67], v[160:163], a[128:143]
    ds_read_b64_tr_b16 a[96:97], v9 offset:8192
    ds_read_b64_tr_b16 a[98:99], v9 offset:8448
    ds_read_b64_tr_b16 a[100:101], v9 offset:12288
    ds_read_b64_tr_b16 a[102:103], v9 offset:12544
    v_mfma_f32_32x32x16_bf16 a[144:159], a[68:71], v[160:163], a[144:159]
    ds_read_b64_tr_b16 a[104:105], v9 offset:8704
    ds_read_b64_tr_b16 a[106:107], v9 offset:8960
    ds_read_b64_tr_b16 a[108:109], v9 offset:12800
    buffer_load_dwordx4 v[144:147], v12, s[48:51], s11 offen offset:0 sc1
    v_mfma_f32_32x32x16_bf16 a[128:143], a[72:75], v[240:243], a[128:143]
    ds_read_b64_tr_b16 a[110:111], v9 offset:13056
    ds_read_b64_tr_b16 a[112:113], v9 offset:10240
    ds_read_b64_tr_b16 a[114:115], v9 offset:10496
    s_add_u32 s11, s12, 15360
    buffer_load_dwordx4 v[148:151], v2, s[48:51], s11 offen offset:0 sc1
    v_mfma_f32_32x32x16_bf16 a[144:159], a[76:79], v[240:243], a[144:159]
    ds_read_b64_tr_b16 a[116:117], v9 offset:14336
    ds_read_b64_tr_b16 a[118:119], v9 offset:14592
    ds_read_b64_tr_b16 a[120:121], v9 offset:10752
    v_mfma_f32_32x32x16_bf16 a[128:143], a[80:83], v[164:167], a[128:143]
    ds_read_b64_tr_b16 a[122:123], v9 offset:11008
    ds_read_b64_tr_b16 a[124:125], v9 offset:14848
    ds_read_b64_tr_b16 a[126:127], v9 offset:15104
    v_mfma_f32_32x32x16_bf16 a[144:159], a[84:87], v[164:167], a[144:159]
    buffer_load_dwordx4 v[224:227], v2, s[48:51], s11 offen offset:1024 sc1
    v_mfma_f32_32x32x16_bf16 a[128:143], a[88:91], v[244:247], a[128:143]
    v_mfma_f32_32x32x16_bf16 a[144:159], a[92:95], v[244:247], a[144:159]
    s_waitcnt lgkmcnt(0)
    v_mfma_f32_32x32x16_bf16 a[128:143], a[96:99], v[168:171], a[128:143]
    s_waitcnt vmcnt(7)
    s_barrier
    v_mfma_f32_32x32x16_bf16 a[144:159], a[100:103], v[168:171], a[144:159]
    buffer_store_dword v30, off, s[48:51], s34 sc1
    v_mfma_f32_32x32x16_bf16 a[128:143], a[104:107], v[248:251], a[128:143]
    buffer_load_dwordx4 v[228:231], v2, s[48:51], s11 offen offset:2048 sc1
    v_mfma_f32_32x32x16_bf16 a[144:159], a[108:111], v[248:251], a[144:159]
    buffer_load_dwordx4 v[152:155], v2, s[48:51], s11 offen offset:3072 sc1
    v_mfma_f32_32x32x16_bf16 a[128:143], a[112:115], v[172:175], a[128:143]
    buffer_load_dwordx4 v[156:159], v12, s[48:51], s11 offen offset:0 sc1
    v_mfma_f32_32x32x16_bf16 a[144:159], a[116:119], v[172:175], a[144:159]
    s_add_u32 s11, s12, 40960
    buffer_load_dwordx4 v[232:235], v2, s[48:51], s11 offen offset:0 sc1
    v_mfma_f32_32x32x16_bf16 a[128:143], a[120:123], v[252:255], a[128:143]
    buffer_load_dwordx4 v[236:239], v2, s[48:51], s11 offen offset:1024 sc1
    v_mfma_f32_32x32x16_bf16 a[144:159], a[124:127], v[252:255], a[144:159]
    buffer_load_dwordx4 v[160:163], v2, s[48:51], s11 offen offset:2048 sc1
    s_mov_b32 s88, 0xbfb8aa3b
    s_mov_b32 s89, 0xbfb8aa3b
    s_mov_b32 s90, 1.0
    s_mov_b32 s91, 1.0
    s_nop 4
    v_accvgpr_read_b32 v32, a128
    s_nop 0
    v_accvgpr_read_b32 v40, a144
    v_accvgpr_read_b32 v33, a129
    v_accvgpr_read_b32 v41, a145
    v_accvgpr_read_b32 v34, a130
    v_accvgpr_read_b32 v42, a146
    v_accvgpr_read_b32 v35, a131
    buffer_load_dwordx4 v[164:167], v2, s[48:51], s11 offen offset:3072 sc1
    v_accvgpr_read_b32 v43, a147
    v_accvgpr_read_b32 v36, a132
    v_accvgpr_read_b32 v44, a148
    v_accvgpr_read_b32 v37, a133
    v_accvgpr_read_b32 v45, a149
    v_accvgpr_read_b32 v38, a134
    v_accvgpr_read_b32 v46, a150
    v_accvgpr_read_b32 v39, a135
    v_accvgpr_read_b32 v47, a151
    v_pk_mul_f32 v[48:49], v[32:33], s[88:89]
    v_pk_mul_f32 v[50:51], v[34:35], s[88:89]
    v_pk_mul_f32 v[52:53], v[36:37], s[88:89]
    v_pk_mul_f32 v[54:55], v[38:39], s[88:89]
    v_exp_f32 v48, v48
    v_exp_f32 v49, v49
    v_exp_f32 v50, v50
    v_exp_f32 v51, v51
    v_exp_f32 v52, v52
    v_exp_f32 v53, v53
    v_exp_f32 v54, v54
    v_exp_f32 v55, v55
    v_pk_mul_f32 v[32:33], v[32:33], v[40:41]
    v_pk_mul_f32 v[34:35], v[34:35], v[42:43]
    v_pk_mul_f32 v[36:37], v[36:37], v[44:45]
    v_pk_mul_f32 v[38:39], v[38:39], v[46:47]
    v_pk_add_f32 v[48:49], v[48:49], s[90:91]
    v_pk_add_f32 v[50:51], v[50:51], s[90:91]
    v_pk_add_f32 v[52:53], v[52:53], s[90:91]
    buffer_load_dwordx4 v[240:243], v12, s[48:51], s11 offen offset:0 sc1
    v_pk_add_f32 v[54:55], v[54:55], s[90:91]
    v_rcp_f32 v48, v48
    v_rcp_f32 v49, v49
    v_rcp_f32 v50, v50
    v_rcp_f32 v51, v51
    v_rcp_f32 v52, v52
    v_rcp_f32 v53, v53
    s_add_u32 s11, s12, 46080
    buffer_load_dwordx4 v[244:247], v2, s[48:51], s11 offen offset:0 sc1
    v_rcp_f32 v54, v54
    v_rcp_f32 v55, v55
    v_pk_mul_f32 v[32:33], v[32:33], v[48:49]
    v_pk_mul_f32 v[34:35], v[34:35], v[50:51]
    v_pk_mul_f32 v[36:37], v[36:37], v[52:53]
    v_pk_mul_f32 v[38:39], v[38:39], v[54:55]
    v_cvt_pk_bf16_f32 v40, v32, v33
    buffer_load_dwordx4 v[168:171], v2, s[48:51], s11 offen offset:1024 sc1
    v_cvt_pk_bf16_f32 v41, v34, v35
    v_cvt_pk_bf16_f32 v42, v36, v37
    v_cvt_pk_bf16_f32 v43, v38, v39
    s_add_u32 s72, s82, 0
    buffer_store_dwordx4 v[40:43], v10, s[48:51], s72 offen offset:0 sc1
    v_accvgpr_read_b32 v32, a136
    s_nop 0
    v_accvgpr_read_b32 v40, a152
    v_accvgpr_read_b32 v33, a137
    v_accvgpr_read_b32 v41, a153
    buffer_load_dwordx4 v[172:175], v2, s[48:51], s11 offen offset:2048 sc1
    v_accvgpr_read_b32 v34, a138
    v_accvgpr_read_b32 v42, a154
    v_accvgpr_read_b32 v35, a139
    v_accvgpr_read_b32 v43, a155
    v_accvgpr_read_b32 v36, a140
    v_accvgpr_read_b32 v44, a156
    v_accvgpr_read_b32 v37, a141
    buffer_load_dwordx4 v[248:251], v2, s[48:51], s11 offen offset:3072 sc1
    v_accvgpr_read_b32 v45, a157
    v_accvgpr_read_b32 v38, a142
    v_accvgpr_read_b32 v46, a158
    v_accvgpr_read_b32 v39, a143
    v_accvgpr_read_b32 v47, a159
    v_pk_mul_f32 v[48:49], v[32:33], s[88:89]
    v_pk_mul_f32 v[50:51], v[34:35], s[88:89]
    buffer_load_dwordx4 v[252:255], v12, s[48:51], s11 offen offset:0 sc1
    v_pk_mul_f32 v[52:53], v[36:37], s[88:89]
    v_pk_mul_f32 v[54:55], v[38:39], s[88:89]
    v_exp_f32 v48, v48
    v_exp_f32 v49, v49
    v_exp_f32 v50, v50
    v_exp_f32 v51, v51
    v_exp_f32 v52, v52
    s_add_u32 s11, s13, 0
    s_add_u32 m0, s92, 0
    s_nop 0
    buffer_load_dwordx4 v2, s[48:51], s11 offen offset:0 sc1 lds
    v_exp_f32 v53, v53
    v_exp_f32 v54, v54
    v_exp_f32 v55, v55
    v_pk_mul_f32 v[32:33], v[32:33], v[40:41]
    v_pk_mul_f32 v[34:35], v[34:35], v[42:43]
    v_pk_mul_f32 v[36:37], v[36:37], v[44:45]
    v_pk_mul_f32 v[38:39], v[38:39], v[46:47]
    buffer_load_dwordx4 v2, s[48:51], s11 offen offset:1024 sc1 lds
    v_pk_add_f32 v[48:49], v[48:49], s[90:91]
    v_pk_add_f32 v[50:51], v[50:51], s[90:91]
    v_pk_add_f32 v[52:53], v[52:53], s[90:91]
    v_pk_add_f32 v[54:55], v[54:55], s[90:91]
    v_rcp_f32 v48, v48
    v_rcp_f32 v49, v49
    v_rcp_f32 v50, v50
    buffer_load_dwordx4 v2, s[48:51], s11 offen offset:2048 sc1 lds
    v_rcp_f32 v51, v51
    v_rcp_f32 v52, v52
    v_rcp_f32 v53, v53
    v_rcp_f32 v54, v54
    v_rcp_f32 v55, v55
    v_pk_mul_f32 v[32:33], v[32:33], v[48:49]
    v_pk_mul_f32 v[34:35], v[34:35], v[50:51]
    buffer_load_dwordx4 v2, s[48:51], s11 offen offset:3072 sc1 lds
    v_pk_mul_f32 v[36:37], v[36:37], v[52:53]
    v_pk_mul_f32 v[38:39], v[38:39], v[54:55]
    v_cvt_pk_bf16_f32 v44, v32, v33
    v_cvt_pk_bf16_f32 v45, v34, v35
    v_cvt_pk_bf16_f32 v46, v36, v37
    v_cvt_pk_bf16_f32 v47, v38, v39
    buffer_store_dwordx4 v[44:47], v10, s[48:51], s72 offen offset:512 sc1
    s_add_u32 s4, s7, 16072704
    v_and_b32 v29, 15, v1
    v_lshlrev_b32 v29, 2, v29
    buffer_load_dword v29, v29, s[48:51], s4 offen sc1
    ds_read_b32 v42, v17 offset:4352
    ds_read_b32 v43, v17 offset:4608
    ds_read_b32 v44, v17 offset:4864
    ds_read_b32 v45, v17 offset:5120
    ds_read_b32 v46, v17 offset:5376
    ds_read_b64 v[32:33], v19 offset:0
    ds_read_b64 v[34:35], v19 offset:256
    ds_read_b64 v[36:37], v19 offset:512
    ds_read_b64 v[38:39], v19 offset:768
    ds_read_b64 v[40:41], v19 offset:1024
    s_add_u32 s72, s64, 1
    s_and_b32 s72, s72, 3
    s_mul_i32 s73, s72, 15360
    s_add_u32 s73, s73, 10240
    v_add_u32 v7, s73, v2
    s_add_u32 s72, s64, 2
    s_and_b32 s72, s72, 3
    s_mul_i32 s73, s72, 15360
    s_add_u32 s73, s73, 5120
    v_add_u32 v8, s73, v2
    s_add_u32 s72, s64, 3
    s_and_b32 s72, s72, 3
    s_mul_i32 s73, s72, 15360
    s_add_u32 s73, s73, 0
    v_add_u32 v9, s73, v2
    s_mul_i32 s73, s64, 15360
    v_add_u32 v11, s73, v2
    v_add_u32 v26, s92, v2
    v_add_u32 v7, 81920, v7
    v_add_u32 v8, 81920, v8
    v_add_u32 v9, 81920, v9
    v_add_u32 v11, 81920, v11
    s_waitcnt lgkmcnt(4)
    v_fma_f32 v56, v32, v42, v56
    s_waitcnt lgkmcnt(3)
    v_fma_f32 v64, v34, v43, v64
    s_waitcnt lgkmcnt(2)
    v_fma_f32 v72, v36, v44, v72
    s_waitcnt lgkmcnt(1)
    v_fma_f32 v80, v38, v45, v80
    s_waitcnt lgkmcnt(0)
    v_fma_f32 v88, v40, v46, v88
    v_fmac_f32_dpp v56, v42, v33 row_ror:8 row_mask:0xf bank_mask:0xf
    v_fmac_f32_dpp v64, v43, v35 row_ror:8 row_mask:0xf bank_mask:0xf
    s_add_u32 m0, s92, 4096
    s_nop 0
    buffer_load_dwordx4 v12, s[48:51], s11 offen offset:0 sc1 lds
    v_fmac_f32_dpp v72, v44, v37 row_ror:8 row_mask:0xf bank_mask:0xf
    v_fmac_f32_dpp v80, v45, v39 row_ror:8 row_mask:0xf bank_mask:0xf
    v_fmac_f32_dpp v88, v46, v41 row_ror:8 row_mask:0xf bank_mask:0xf
    v_fma_f32 v57, v32, v56, v57
    v_fma_f32 v65, v34, v64, v65
    v_fma_f32 v73, v36, v72, v73
    v_fma_f32 v81, v38, v80, v81
    s_add_u32 s11, s13, 5120
    s_add_u32 m0, s92, 5120
    s_nop 0
    buffer_load_dwordx4 v2, s[48:51], s11 offen offset:0 sc1 lds
    v_fma_f32 v89, v40, v88, v89
    v_fmac_f32_dpp v57, v56, v33 row_ror:8 row_mask:0xf bank_mask:0xf
    v_fmac_f32_dpp v65, v64, v35 row_ror:8 row_mask:0xf bank_mask:0xf
    v_fmac_f32_dpp v73, v72, v37 row_ror:8 row_mask:0xf bank_mask:0xf
    v_fmac_f32_dpp v81, v80, v39 row_ror:8 row_mask:0xf bank_mask:0xf
    v_fmac_f32_dpp v89, v88, v41 row_ror:8 row_mask:0xf bank_mask:0xf
    v_fma_f32 v58, v32, v57, v58
    buffer_load_dwordx4 v2, s[48:51], s11 offen offset:1024 sc1 lds
    v_fma_f32 v66, v34, v65, v66
    v_fma_f32 v74, v36, v73, v74
    v_fma_f32 v82, v38, v81, v82
    v_fma_f32 v90, v40, v89, v90
    v_fmac_f32_dpp v58, v57, v33 row_ror:8 row_mask:0xf bank_mask:0xf
    v_fmac_f32_dpp v66, v65, v35 row_ror:8 row_mask:0xf bank_mask:0xf
    v_fmac_f32_dpp v74, v73, v37 row_ror:8 row_mask:0xf bank_mask:0xf
    buffer_load_dwordx4 v2, s[48:51], s11 offen offset:2048 sc1 lds
    v_fmac_f32_dpp v82, v81, v39 row_ror:8 row_mask:0xf bank_mask:0xf
    v_fmac_f32_dpp v90, v89, v41 row_ror:8 row_mask:0xf bank_mask:0xf
    v_fma_f32 v59, v32, v58, v59
    v_fma_f32 v67, v34, v66, v67
    v_fma_f32 v75, v36, v74, v75
    v_fma_f32 v83, v38, v82, v83
    v_fma_f32 v91, v40, v90, v91
    buffer_load_dwordx4 v2, s[48:51], s11 offen offset:3072 sc1 lds
    v_fmac_f32_dpp v59, v58, v33 row_ror:8 row_mask:0xf bank_mask:0xf
    v_fmac_f32_dpp v67, v66, v35 row_ror:8 row_mask:0xf bank_mask:0xf
    v_fmac_f32_dpp v75, v74, v37 row_ror:8 row_mask:0xf bank_mask:0xf
    v_fmac_f32_dpp v83, v82, v39 row_ror:8 row_mask:0xf bank_mask:0xf
    v_fmac_f32_dpp v91, v90, v41 row_ror:8 row_mask:0xf bank_mask:0xf
    v_fma_f32 v60, v32, v59, v60
    v_fma_f32 v68, v34, v67, v68
    s_add_u32 m0, s92, 9216
    s_nop 0
    buffer_load_dwordx4 v12, s[48:51], s11 offen offset:0 sc1 lds
    v_fma_f32 v76, v36, v75, v76
    v_fma_f32 v84, v38, v83, v84
    v_fma_f32 v92, v40, v91, v92
    v_fmac_f32_dpp v60, v59, v33 row_ror:8 row_mask:0xf bank_mask:0xf
    v_fmac_f32_dpp v68, v67, v35 row_ror:8 row_mask:0xf bank_mask:0xf
    v_fmac_f32_dpp v76, v75, v37 row_ror:8 row_mask:0xf bank_mask:0xf
    v_fmac_f32_dpp v84, v83, v39 row_ror:8 row_mask:0xf bank_mask:0xf
    v_fmac_f32_dpp v92, v91, v41 row_ror:8 row_mask:0xf bank_mask:0xf
    v_fma_f32 v61, v32, v60, v61
    v_fma_f32 v69, v34, v68, v69
    v_fma_f32 v77, v36, v76, v77
    v_fma_f32 v85, v38, v84, v85
    v_fma_f32 v93, v40, v92, v93
    v_fmac_f32_dpp v61, v60, v33 row_ror:8 row_mask:0xf bank_mask:0xf
    v_fmac_f32_dpp v69, v68, v35 row_ror:8 row_mask:0xf bank_mask:0xf
    v_fmac_f32_dpp v77, v76, v37 row_ror:8 row_mask:0xf bank_mask:0xf
    v_fmac_f32_dpp v85, v84, v39 row_ror:8 row_mask:0xf bank_mask:0xf
    v_fmac_f32_dpp v93, v92, v41 row_ror:8 row_mask:0xf bank_mask:0xf
    v_fma_f32 v62, v32, v61, v62
    v_fma_f32 v70, v34, v69, v70
    v_fma_f32 v78, v36, v77, v78
    v_fma_f32 v86, v38, v85, v86
    v_fma_f32 v94, v40, v93, v94
    v_fmac_f32_dpp v62, v61, v33 row_ror:8 row_mask:0xf bank_mask:0xf
    v_fmac_f32_dpp v70, v69, v35 row_ror:8 row_mask:0xf bank_mask:0xf
    v_fmac_f32_dpp v78, v77, v37 row_ror:8 row_mask:0xf bank_mask:0xf
    s_add_u32 s11, s13, 10240
    s_add_u32 m0, s92, 10240
    s_nop 0
    buffer_load_dwordx4 v2, s[48:51], s11 offen offset:0 sc1 lds
    v_fmac_f32_dpp v86, v85, v39 row_ror:8 row_mask:0xf bank_mask:0xf
    v_fmac_f32_dpp v94, v93, v41 row_ror:8 row_mask:0xf bank_mask:0xf
    v_fma_f32 v63, v32, v62, v63
    v_fma_f32 v71, v34, v70, v71
    v_fma_f32 v79, v36, v78, v79
    v_fma_f32 v87, v38, v86, v87
    v_fma_f32 v95, v40, v94, v95
    v_fmac_f32_dpp v63, v62, v33 row_ror:8 row_mask:0xf bank_mask:0xf
    v_fmac_f32_dpp v71, v70, v35 row_ror:8 row_mask:0xf bank_mask:0xf
    v_fmac_f32_dpp v79, v78, v37 row_ror:8 row_mask:0xf bank_mask:0xf
    v_fmac_f32_dpp v87, v86, v39 row_ror:8 row_mask:0xf bank_mask:0xf
    v_fmac_f32_dpp v95, v94, v41 row_ror:8 row_mask:0xf bank_mask:0xf
    s_waitcnt vmcnt(7)
    v_cmp_ne_u32 vcc, s69, v29
    s_cbranch_vccz L_ok4
    s_mov_b32 s94, 262144
L_rt4:
    s_sleep 1
    s_add_u32 s4, s7, 16072704
    v_and_b32 v29, 15, v1
    v_lshlrev_b32 v29, 2, v29
    buffer_load_dword v29, v29, s[48:51], s4 offen sc1
    s_waitcnt vmcnt(0)
    s_nop 1
    v_cmp_ne_u32 vcc, s69, v29
    s_cbranch_vccz L_ok4
    s_sub_u32 s94, s94, 1
    s_cmp_lg_u32 s94, 0
    s_cbranch_scc1 L_rt4
    s_nop 7
L_ok4:
    s_add_u32 s8, s9, 0
    buffer_load_dwordx4 a[80:83], v3, s[48:51], s8 offen sc1
    buffer_load_dwordx4 a[84:87], v4, s[48:51], s8 offen sc1
    buffer_load_dwordx4 a[88:91], v5, s[48:51], s8 offen sc1
    buffer_load_dwordx4 a[92:95], v6, s[48:51], s8 offen sc1
    s_add_u32 s8, s9, 4096
    buffer_load_dwordx4 a[96:99], v3, s[48:51], s8 offen sc1
    buffer_load_dwordx4 a[100:103], v4, s[48:51], s8 offen sc1
    buffer_load_dwordx4 a[104:107], v5, s[48:51], s8 offen sc1
    buffer_load_dwordx4 a[108:111], v6, s[48:51], s8 offen sc1
    s_add_u32 s8, s9, 16384
    buffer_load_dwordx4 a[112:115], v3, s[48:51], s8 offen sc1
    buffer_load_dwordx4 a[116:119], v4, s[48:51], s8 offen sc1
    buffer_load_dwordx4 a[120:123], v5, s[48:51], s8 offen sc1
    buffer_load_dwordx4 a[124:127], v6, s[48:51], s8 offen sc1
    s_mov_b32 s76, 0
    s_mov_b32 s77, 2560
    s_mov_b32 s78, 5120
    s_mov_b32 s79, 7680
    s_waitcnt vmcnt(11)
    v_mfma_f32_16x16x32_bf16 a[0:3], a[80:83], a[196:199], 0
    v_cvt_pk_bf16_f32 v32, v56, v57
    v_cvt_pk_bf16_f32 v33, v58, v59
    v_mfma_f32_16x16x32_bf16 a[4:7], a[80:83], a[200:203], 0
    s_add_u32 s8, s9, 20480
    buffer_load_dwordx4 a[128:131], v3, s[48:51], s8 offen sc1
    v_cvt_pk_bf16_f32 v34, v60, v61
    v_cvt_pk_bf16_f32 v35, v62, v63
    v_mfma_f32_16x16x32_bf16 a[8:11], a[80:83], a[204:207], 0
    buffer_load_dwordx4 a[132:135], v4, s[48:51], s8 offen sc1
    v_cvt_pk_bf16_f32 v36, v64, v65
    v_cvt_pk_bf16_f32 v37, v66, v67
    v_mfma_f32_16x16x32_bf16 a[12:15], a[80:83], a[208:211], 0
    buffer_load_dwordx4 a[136:139], v5, s[48:51], s8 offen sc1
    v_cvt_pk_bf16_f32 v38, v68, v69
    v_cvt_pk_bf16_f32 v39, v70, v71
    v_mfma_f32_16x16x32_bf16 a[16:19], a[80:83], a[212:215], 0
    buffer_load_dwordx4 a[140:143], v6, s[48:51], s8 offen sc1
    v_cvt_pk_bf16_f32 v40, v72, v73
    v_cvt_pk_bf16_f32 v41, v74, v75
    v_cvt_pk_bf16_f32 v42, v76, v77
    s_waitcnt vmcnt(14)
    v_mfma_f32_16x16x32_bf16 a[20:23], a[84:87], a[196:199], 0
    v_cvt_pk_bf16_f32 v43, v78, v79
    v_cvt_pk_bf16_f32 v44, v80, v81
    v_mfma_f32_16x16x32_bf16 a[24:27], a[84:87], a[200:203], 0
    v_cvt_pk_bf16_f32 v45, v82, v83
    v_cvt_pk_bf16_f32 v46, v84, v85
    v_mfma_f32_16x16x32_bf16 a[28:31], a[84:87], a[204:207], 0
    v_cvt_pk_bf16_f32 v47, v86, v87
    v_cvt_pk_bf16_f32 v48, v88, v89
    v_mfma_f32_16x16x32_bf16 a[32:35], a[84:87], a[208:211], 0
    v_cvt_pk_bf16_f32 v49, v90, v91
    v_cvt_pk_bf16_f32 v50, v92, v93
    v_cvt_pk_bf16_f32 v51, v94, v95
    v_mfma_f32_16x16x32_bf16 a[36:39], a[84:87], a[212:215], 0
    ds_write_b64 v23, v[32:33] offset:0
    ds_write_b64 v23, v[34:35] offset:512
    s_waitcnt vmcnt(13)
    v_mfma_f32_16x16x32_bf16 a[40:43], a[88:91], a[196:199], 0
    s_add_u32 m0, s92, 10240
    s_nop 0
    buffer_load_dwordx4 v2, s[48:51], s11 offen offset:1024 sc1 lds
    v_mfma_f32_16x16x32_bf16 a[44:47], a[88:91], a[200:203], 0
    ds_write_b64 v23, v[36:37] offset:1024
    ds_write_b64 v23, v[38:39] offset:1536
    v_mfma_f32_16x16x32_bf16 a[48:51], a[88:91], a[204:207], 0
    ds_write_b64 v23, v[40:41] offset:2048
    ds_write_b64 v23, v[42:43] offset:2560
    v_mfma_f32_16x16x32_bf16 a[52:55], a[88:91], a[208:211], 0
    ds_write_b64 v23, v[44:45] offset:3072
    ds_write_b64 v23, v[46:47] offset:3584
    v_mfma_f32_16x16x32_bf16 a[56:59], a[88:91], a[212:215], 0
    buffer_load_dwordx4 v2, s[48:51], s11 offen offset:2048 sc1 lds
    s_waitcnt vmcnt(14)
    v_mfma_f32_16x16x32_bf16 a[60:63], a[92:95], a[196:199], 0
    ds_write_b64 v23, v[48:49] offset:4096
    ds_write_b64 v23, v[50:51] offset:4608
    v_mfma_f32_16x16x32_bf16 a[64:67], a[92:95], a[200:203], 0
    ds_read_b64_tr_b16 v[56:57], v24 offset:0
    ds_read_b64_tr_b16 v[58:59], v24 offset:128
    v_mfma_f32_16x16x32_bf16 a[68:71], a[92:95], a[204:207], 0
    ds_read_b64_tr_b16 v[60:61], v24 offset:1024
    ds_read_b64_tr_b16 v[62:63], v24 offset:1152
    v_mfma_f32_16x16x32_bf16 a[72:75], a[92:95], a[208:211], 0
    buffer_load_dwordx4 v2, s[48:51], s11 offen offset:3072 sc1 lds
    v_mfma_f32_16x16x32_bf16 a[76:79], a[92:95], a[212:215], 0
    s_barrier
    buffer_store_dword v30, off, s[48:51], s35 sc1
    ds_read_b64_tr_b16 v[64:65], v24 offset:2048
    ds_read_b64_tr_b16 v[66:67], v24 offset:2176
    s_waitcnt vmcnt(15)
    v_mfma_f32_16x16x32_bf16 a[0:3], a[96:99], a[216:219], a[0:3]
    ds_read_b64_tr_b16 v[68:69], v24 offset:3072
    ds_read_b64_tr_b16 v[70:71], v24 offset:3200
    v_mfma_f32_16x16x32_bf16 a[4:7], a[96:99], a[220:223], a[4:7]
    s_add_u32 s8, s9, 24576
    buffer_load_dwordx4 a[144:147], v3, s[48:51], s8 offen sc1
    v_mfma_f32_16x16x32_bf16 a[8:11], a[96:99], a[224:227], a[8:11]
    buffer_load_dwordx4 a[148:151], v4, s[48:51], s8 offen sc1
    v_mfma_f32_16x16x32_bf16 a[12:15], a[96:99], a[228:231], a[12:15]
    buffer_load_dwordx4 a[152:155], v5, s[48:51], s8 offen sc1
    v_mfma_f32_16x16x32_bf16 a[16:19], a[96:99], a[232:235], a[16:19]
    buffer_load_dwordx4 a[156:159], v6, s[48:51], s8 offen sc1
    s_waitcnt vmcnt(18)
    v_mfma_f32_16x16x32_bf16 a[20:23], a[100:103], a[216:219], a[20:23]
    ds_read_b64_tr_b16 v[72:73], v24 offset:4096
    ds_read_b64_tr_b16 v[74:75], v24 offset:4224
    v_mfma_f32_16x16x32_bf16 a[24:27], a[100:103], a[220:223], a[24:27]
    v_mfma_f32_16x16x32_bf16 a[28:31], a[100:103], a[224:227], a[28:31]
    v_mfma_f32_16x16x32_bf16 a[32:35], a[100:103], a[228:231], a[32:35]
    v_mfma_f32_16x16x32_bf16 a[36:39], a[100:103], a[232:235], a[36:39]
    s_waitcnt vmcnt(17)
    v_mfma_f32_16x16x32_bf16 a[40:43], a[104:107], a[216:219], a[40:43]
    s_add_u32 m0, s92, 14336
    s_nop 0
    buffer_load_dwordx4 v12, s[48:51], s11 offen offset:0 sc1 lds
    s_waitcnt lgkmcnt(8)
    buffer_store_dwordx4 v[56:59], v25, s[48:51], s24 offen sc1
    v_mfma_f32_16x16x32_bf16 a[44:47], a[104:107], a[220:223], a[44:47]
    v_mfma_f32_16x16x32_bf16 a[48:51], a[104:107], a[224:227], a[48:51]
    s_waitcnt lgkmcnt(6)
    buffer_store_dwordx4 v[60:63], v25, s[48:51], s25 offen sc1
    v_mfma_f32_16x16x32_bf16 a[52:55], a[104:107], a[228:231], a[52:55]
    v_mfma_f32_16x16x32_bf16 a[56:59], a[104:107], a[232:235], a[56:59]
    s_waitcnt lgkmcnt(4)
    buffer_store_dwordx4 v[64:67], v25, s[48:51], s26 offen sc1
    s_waitcnt vmcnt(20)
    v_mfma_f32_16x16x32_bf16 a[60:63], a[108:111], a[216:219], a[60:63]
    v_mfma_f32_16x16x32_bf16 a[64:67], a[108:111], a[220:223], a[64:67]
    s_waitcnt lgkmcnt(2)
    buffer_store_dwordx4 v[68:71], v25, s[48:51], s27 offen sc1
    v_mfma_f32_16x16x32_bf16 a[68:71], a[108:111], a[224:227], a[68:71]
    v_mfma_f32_16x16x32_bf16 a[72:75], a[108:111], a[228:231], a[72:75]
    s_waitcnt lgkmcnt(0)
    buffer_store_dwordx4 v[72:75], v25, s[48:51], s30 offen sc1
    v_mfma_f32_16x16x32_bf16 a[76:79], a[108:111], a[232:235], a[76:79]
    s_waitcnt vmcnt(21)
    v_mfma_f32_16x16x32_bf16 a[0:3], a[112:115], a[236:239], a[0:3]
    v_mfma_f32_16x16x32_bf16 a[4:7], a[112:115], a[240:243], a[4:7]
    s_add_u32 s8, s9, 28672
    buffer_load_dwordx4 a[80:83], v3, s[48:51], s8 offen sc1
    v_mfma_f32_16x16x32_bf16 a[8:11], a[112:115], a[244:247], a[8:11]
    buffer_load_dwordx4 a[84:87], v4, s[48:51], s8 offen sc1
    v_mfma_f32_16x16x32_bf16 a[12:15], a[112:115], a[248:251], a[12:15]
    buffer_load_dwordx4 a[88:91], v5, s[48:51], s8 offen sc1
    v_mfma_f32_16x16x32_bf16 a[16:19], a[112:115], a[252:255], a[16:19]
    buffer_load_dwordx4 a[92:95], v6, s[48:51], s8 offen sc1
    s_waitcnt vmcnt(24)
    v_mfma_f32_16x16x32_bf16 a[20:23], a[116:119], a[236:239], a[20:23]
    v_mfma_f32_16x16x32_bf16 a[24:27], a[116:119], a[240:243], a[24:27]
    v_mfma_f32_16x16x32_bf16 a[28:31], a[116:119], a[244:247], a[28:31]
    v_mfma_f32_16x16x32_bf16 a[32:35], a[116:119], a[248:251], a[32:35]
    s_add_u32 s11, s13, 15360
    s_add_u32 m0, s92, 15360
    s_nop 0
    buffer_load_dwordx4 v2, s[48:51], s11 offen offset:0 sc1 lds
    v_mfma_f32_16x16x32_bf16 a[36:39], a[116:119], a[252:255], a[36:39]
    s_waitcnt vmcnt(24)
    v_mfma_f32_16x16x32_bf16 a[40:43], a[120:123], a[236:239], a[40:43]
    v_mfma_f32_16x16x32_bf16 a[44:47], a[120:123], a[240:243], a[44:47]
    v_mfma_f32_16x16x32_bf16 a[48:51], a[120:123], a[244:247], a[48:51]
    v_mfma_f32_16x16x32_bf16 a[52:55], a[120:123], a[248:251], a[52:55]
    v_mfma_f32_16x16x32_bf16 a[56:59], a[120:123], a[252:255], a[56:59]
    s_waitcnt vmcnt(23)
    v_mfma_f32_16x16x32_bf16 a[60:63], a[124:127], a[236:239], a[60:63]
    v_mfma_f32_16x16x32_bf16 a[64:67], a[124:127], a[240:243], a[64:67]
    v_mfma_f32_16x16x32_bf16 a[68:71], a[124:127], a[244:247], a[68:71]
    v_mfma_f32_16x16x32_bf16 a[72:75], a[124:127], a[248:251], a[72:75]
    v_mfma_f32_16x16x32_bf16 a[76:79], a[124:127], a[252:255], a[76:79]
    s_waitcnt vmcnt(5)
    s_barrier
    buffer_store_dword v30, off, s[48:51], s6 sc1
    v_mfma_f32_16x16x32_bf16 a[0:3], a[128:131], a[160:163], a[0:3]
    v_and_b32 v40, 15, v1
    v_lshrrev_b32 v41, 4, v1
    s_lshl_b32 s72, s67, 6
    v_mfma_f32_16x16x32_bf16 a[4:7], a[128:131], a[164:167], a[4:7]
    s_add_u32 s8, s9, 40960
    buffer_load_dwordx4 a[96:99], v3, s[48:51], s8 offen sc1
    s_lshr_b32 s73, s64, 1
    s_lshl_b32 s73, s73, 5
    v_mfma_f32_16x16x32_bf16 a[8:11], a[128:131], a[168:171], a[8:11]
    s_add_u32 s4, s7, 16064512
    v_and_b32 v29, 15, v1
    v_lshlrev_b32 v29, 2, v29
    buffer_load_dword v29, v29, s[48:51], s4 offen sc1
    s_add_u32 s72, s72, s73
    s_and_b32 s73, s64, 1
    v_mfma_f32_16x16x32_bf16 a[12:15], a[128:131], a[172:175], a[12:15]
    buffer_load_dwordx4 a[100:103], v4, s[48:51], s8 offen sc1
    s_lshl_b32 s73, s73, 2
    s_add_u32 s72, s72, s73
    v_mfma_f32_16x16x32_bf16 a[16:19], a[128:131], a[176:179], a[16:19]
    buffer_load_dwordx4 a[104:107], v5, s[48:51], s8 offen sc1
    s_mul_i32 s97, s64, 3072
    s_add_u32 s97, s97, 143360
    v_mfma_f32_16x16x32_bf16 a[20:23], a[132:135], a[160:163], a[20:23]
    buffer_load_dwordx4 a[108:111], v6, s[48:51], s8 offen sc1
    v_mul_u32_u24 v25, 640, v41
    v_lshl_add_u32 v25, v40, 1, v25
    v_mfma_f32_16x16x32_bf16 a[24:27], a[132:135], a[164:167], a[24:27]
    v_add_u32 v25, s97, v25
    v_lshl_add_u32 v41, v41, 3, s72
    v_mfma_f32_16x16x32_bf16 a[28:31], a[132:135], a[168:171], a[28:31]
    s_mul_i32 s73, s68, 80
    v_add_u32 v40, s73, v40
    v_mfma_f32_16x16x32_bf16 a[32:35], a[132:135], a[172:175], a[32:35]
    buffer_load_dwordx4 v2, s[48:51], s11 offen offset:1024 sc1 lds
    v_mul_u32_u24 v42, 640, v41
    v_add_u32 v42, v42, v40
    v_mfma_f32_16x16x32_bf16 a[36:39], a[132:135], a[176:179], a[36:39]
    v_lshlrev_b32 v13, 2, v42
    v_lshlrev_b32 v15, 3, v41
    v_mfma_f32_16x16x32_bf16 a[40:43], a[136:139], a[160:163], a[40:43]
    v_lshlrev_b32 v16, 1, v40
    s_mul_i32 s72, s72, 1280
    v_mfma_f32_16x16x32_bf16 a[44:47], a[136:139], a[164:167], a[44:47]
    s_mul_i32 s73, s68, 160
    s_add_u32 s98, s72, s73
    v_mfma_f32_16x16x32_bf16 a[48:51], a[136:139], a[168:171], a[48:51]
    buffer_load_dwordx4 v2, s[48:51], s11 offen offset:2048 sc1 lds
    s_add_u32 s98, s98, 4096
    s_mov_b32 s73, 6554
    v_mfma_f32_16x16x32_bf16 a[52:55], a[136:139], a[172:175], a[52:55]
    v_add_u32 v43, 0, v1
    v_mul_u32_u24 v44, s73, v43
    v_mfma_f32_16x16x32_bf16 a[56:59], a[136:139], a[176:179], a[56:59]
    v_lshrrev_b32 v44, 16, v44
    v_mul_u32_u24 v45, 10, v44
    v_mfma_f32_16x16x32_bf16 a[60:63], a[140:143], a[160:163], a[60:63]
    v_sub_u32 v45, v43, v45
    v_lshlrev_b32 v45, 4, v45
    v_mfma_f32_16x16x32_bf16 a[64:67], a[140:143], a[164:167], a[64:67]
    buffer_load_dwordx4 v2, s[48:51], s11 offen offset:3072 sc1 lds
    v_and_b32 v43, 12, v44
    v_mfma_f32_16x16x32_bf16 a[68:71], a[140:143], a[168:171], a[68:71]
    v_add_u32 v44, v43, v44
    v_mul_u32_u24 v44, 1280, v44
    v_mfma_f32_16x16x32_bf16 a[72:75], a[140:143], a[172:175], a[72:75]
    v_add_u32 v22, v44, v45
    v_add_u32 v43, 64, v1
    v_mfma_f32_16x16x32_bf16 a[76:79], a[140:143], a[176:179], a[76:79]
    v_mul_u32_u24 v44, s73, v43
    v_lshrrev_b32 v44, 16, v44
    v_mfma_f32_16x16x32_bf16 a[0:3], a[144:147], v[96:99], a[0:3]
    v_mul_u32_u24 v45, 10, v44
    v_sub_u32 v45, v43, v45
    v_mfma_f32_16x16x32_bf16 a[4:7], a[144:147], v[100:103], a[4:7]
    s_add_u32 s8, s9, 45056
    buffer_load_dwordx4 a[112:115], v3, s[48:51], s8 offen sc1
    v_lshlrev_b32 v45, 4, v45
    v_and_b32 v43, 12, v44
    v_mfma_f32_16x16x32_bf16 a[8:11], a[144:147], v[176:179], a[8:11]
    buffer_load_dwordx4 a[116:119], v4, s[48:51], s8 offen sc1
    v_add_u32 v44, v43, v44
    v_mul_u32_u24 v44, 1280, v44
    v_mfma_f32_16x16x32_bf16 a[12:15], a[144:147], v[180:183], a[12:15]
    buffer_load_dwordx4 a[120:123], v5, s[48:51], s8 offen sc1
    v_add_u32 v23, v44, v45
    v_add_u32 v43, 128, v1
    v_mfma_f32_16x16x32_bf16 a[16:19], a[144:147], v[104:107], a[16:19]
    buffer_load_dwordx4 a[124:127], v6, s[48:51], s8 offen sc1
    v_mul_u32_u24 v44, s73, v43
    v_lshrrev_b32 v44, 16, v44
    v_mfma_f32_16x16x32_bf16 a[20:23], a[148:151], v[96:99], a[20:23]
    v_mul_u32_u24 v45, 10, v44
    v_sub_u32 v45, v43, v45
    v_mfma_f32_16x16x32_bf16 a[24:27], a[148:151], v[100:103], a[24:27]
    v_lshlrev_b32 v45, 4, v45
    v_and_b32 v43, 12, v44
    v_mfma_f32_16x16x32_bf16 a[28:31], a[148:151], v[176:179], a[28:31]
    v_add_u32 v44, v43, v44
    v_mul_u32_u24 v44, 1280, v44
    v_mfma_f32_16x16x32_bf16 a[32:35], a[148:151], v[180:183], a[32:35]
    s_add_u32 m0, s92, 19456
    s_nop 0
    buffer_load_dwordx4 v12, s[48:51], s11 offen offset:0 sc1 lds
    v_add_u32 v24, v44, v45
    v_mov_b32 v43, 1073741824
    v_mfma_f32_16x16x32_bf16 a[36:39], a[148:151], v[104:107], a[36:39]
    v_cmp_gt_u32 vcc, 32, v1
    s_nop 1
    v_cndmask_b32 v24, v43, v24, vcc
    v_mfma_f32_16x16x32_bf16 a[40:43], a[152:155], v[96:99], a[40:43]
    v_mfma_f32_16x16x32_bf16 a[44:47], a[152:155], v[100:103], a[44:47]
    v_mfma_f32_16x16x32_bf16 a[48:51], a[152:155], v[176:179], a[48:51]
    v_mfma_f32_16x16x32_bf16 a[52:55], a[152:155], v[180:183], a[52:55]
    v_mfma_f32_16x16x32_bf16 a[56:59], a[152:155], v[104:107], a[56:59]
    v_mfma_f32_16x16x32_bf16 a[60:63], a[156:159], v[96:99], a[60:63]
    v_mfma_f32_16x16x32_bf16 a[64:67], a[156:159], v[100:103], a[64:67]
    v_mfma_f32_16x16x32_bf16 a[68:71], a[156:159], v[176:179], a[68:71]
    v_mfma_f32_16x16x32_bf16 a[72:75], a[156:159], v[180:183], a[72:75]
    v_mfma_f32_16x16x32_bf16 a[76:79], a[156:159], v[104:107], a[76:79]
    s_waitcnt vmcnt(11)
    v_cmp_ne_u32 vcc, s69, v29
    s_cbranch_vccz L_ok5
    s_mov_b32 s94, 262144
L_rt5:
    s_sleep 1
    s_add_u32 s4, s7, 16064512
    v_and_b32 v29, 15, v1
    v_lshlrev_b32 v29, 2, v29
    buffer_load_dword v29, v29, s[48:51], s4 offen sc1
    s_waitcnt vmcnt(0)
    s_nop 1
    v_cmp_ne_u32 vcc, s69, v29
    s_cbranch_vccz L_ok5
    s_sub_u32 s94, s94, 1
    s_cmp_lg_u32 s94, 0
    s_cbranch_scc1 L_rt5
    s_nop 7
L_ok5:
    v_mfma_f32_16x16x32_bf16 a[0:3], a[80:83], v[108:111], a[0:3]
    v_mfma_f32_16x16x32_bf16 a[4:7], a[80:83], v[184:187], a[4:7]
    s_add_u32 s8, s9, 8192
    buffer_load_dwordx4 a[128:131], v3, s[48:51], s8 offen sc1
    v_mfma_f32_16x16x32_bf16 a[8:11], a[80:83], v[188:191], a[8:11]
    buffer_load_dwordx4 a[132:135], v4, s[48:51], s8 offen sc1
    v_mfma_f32_16x16x32_bf16 a[12:15], a[80:83], v[112:115], a[12:15]
    buffer_load_dwordx4 a[136:139], v5, s[48:51], s8 offen sc1
    v_mfma_f32_16x16x32_bf16 a[16:19], a[80:83], v[116:119], a[16:19]
    buffer_load_dwordx4 a[140:143], v6, s[48:51], s8 offen sc1
    v_mfma_f32_16x16x32_bf16 a[20:23], a[84:87], v[108:111], a[20:23]
    v_mfma_f32_16x16x32_bf16 a[24:27], a[84:87], v[184:187], a[24:27]
    v_mfma_f32_16x16x32_bf16 a[28:31], a[84:87], v[188:191], a[28:31]
    v_mfma_f32_16x16x32_bf16 a[32:35], a[84:87], v[112:115], a[32:35]
    v_mfma_f32_16x16x32_bf16 a[36:39], a[84:87], v[116:119], a[36:39]
    v_mfma_f32_16x16x32_bf16 a[40:43], a[88:91], v[108:111], a[40:43]
    v_mfma_f32_16x16x32_bf16 a[44:47], a[88:91], v[184:187], a[44:47]
    v_mfma_f32_16x16x32_bf16 a[48:51], a[88:91], v[188:191], a[48:51]
    v_mfma_f32_16x16x32_bf16 a[52:55], a[88:91], v[112:115], a[52:55]
    v_mfma_f32_16x16x32_bf16 a[56:59], a[88:91], v[116:119], a[56:59]
    v_mfma_f32_16x16x32_bf16 a[60:63], a[92:95], v[108:111], a[60:63]
    v_mfma_f32_16x16x32_bf16 a[64:67], a[92:95], v[184:187], a[64:67]
    v_mfma_f32_16x16x32_bf16 a[68:71], a[92:95], v[188:191], a[68:71]
    v_mfma_f32_16x16x32_bf16 a[72:75], a[92:95], v[112:115], a[72:75]
    v_mfma_f32_16x16x32_bf16 a[76:79], a[92:95], v[116:119], a[76:79]
    v_mfma_f32_16x16x32_bf16 a[0:3], a[96:99], v[192:195], a[0:3]
    v_mfma_f32_16x16x32_bf16 a[4:7], a[96:99], v[196:199], a[4:7]
    s_add_u32 s8, s9, 12288
    buffer_load_dwordx4 a[144:147], v3, s[48:51], s8 offen sc1
    v_mfma_f32_16x16x32_bf16 a[8:11], a[96:99], v[120:123], a[8:11]
    s_add_u32 m0, s97, 0
    s_nop 0
    buffer_load_dwordx4 v22, s[36:39], s98 offen lds
    v_mfma_f32_16x16x32_bf16 a[12:15], a[96:99], v[124:127], a[12:15]
    buffer_load_dwordx4 a[148:151], v4, s[48:51], s8 offen sc1
    v_mfma_f32_16x16x32_bf16 a[16:19], a[96:99], v[200:203], a[16:19]
    buffer_load_dwordx4 a[152:155], v5, s[48:51], s8 offen sc1
    s_waitcnt vmcnt(18)
    v_mfma_f32_16x16x32_bf16 a[20:23], a[100:103], v[192:195], a[20:23]
    buffer_load_dwordx4 a[156:159], v6, s[48:51], s8 offen sc1
    v_mfma_f32_16x16x32_bf16 a[24:27], a[100:103], v[196:199], a[24:27]
    v_mfma_f32_16x16x32_bf16 a[28:31], a[100:103], v[120:123], a[28:31]
    v_mfma_f32_16x16x32_bf16 a[32:35], a[100:103], v[124:127], a[32:35]
    v_mfma_f32_16x16x32_bf16 a[36:39], a[100:103], v[200:203], a[36:39]
    s_add_u32 m0, s97, 1024
    s_nop 0
    buffer_load_dwordx4 v23, s[36:39], s98 offen lds
    s_waitcnt vmcnt(19)
    v_mfma_f32_16x16x32_bf16 a[40:43], a[104:107], v[192:195], a[40:43]
    v_mfma_f32_16x16x32_bf16 a[44:47], a[104:107], v[196:199], a[44:47]
    v_mfma_f32_16x16x32_bf16 a[48:51], a[104:107], v[120:123], a[48:51]
    v_mfma_f32_16x16x32_bf16 a[52:55], a[104:107], v[124:127], a[52:55]
    v_mfma_f32_16x16x32_bf16 a[56:59], a[104:107], v[200:203], a[56:59]
    s_waitcnt vmcnt(18)
    v_mfma_f32_16x16x32_bf16 a[60:63], a[108:111], v[192:195], a[60:63]
    v_mfma_f32_16x16x32_bf16 a[64:67], a[108:111], v[196:199], a[64:67]
    v_mfma_f32_16x16x32_bf16 a[68:71], a[108:111], v[120:123], a[68:71]
    v_mfma_f32_16x16x32_bf16 a[72:75], a[108:111], v[124:127], a[72:75]
    v_mfma_f32_16x16x32_bf16 a[76:79], a[108:111], v[200:203], a[76:79]
    s_add_u32 m0, s97, 2048
    s_nop 0
    buffer_load_dwordx4 v24, s[36:39], s98 offen lds
    s_waitcnt vmcnt(15)
    v_mfma_f32_16x16x32_bf16 a[0:3], a[112:115], v[204:207], a[0:3]
    v_mfma_f32_16x16x32_bf16 a[4:7], a[112:115], v[128:131], a[4:7]
    s_add_u32 s8, s9, 32768
    buffer_load_dwordx4 a[80:83], v3, s[48:51], s8 offen sc1
    v_mfma_f32_16x16x32_bf16 a[8:11], a[112:115], v[132:135], a[8:11]
    s_add_u32 s4, s7, 16060416
    v_and_b32 v29, 15, v1
    v_lshlrev_b32 v29, 2, v29
    buffer_load_dword v29, v29, s[48:51], s4 offen sc1
    v_mfma_f32_16x16x32_bf16 a[12:15], a[112:115], v[208:211], a[12:15]
    buffer_load_dwordx4 a[84:87], v4, s[48:51], s8 offen sc1
    v_mfma_f32_16x16x32_bf16 a[16:19], a[112:115], v[212:215], a[16:19]
    global_load_ushort v17, v16, s[20:21] offset:0
    s_waitcnt vmcnt(18)
    v_mfma_f32_16x16x32_bf16 a[20:23], a[116:119], v[204:207], a[20:23]
    buffer_load_dwordx4 a[88:91], v5, s[48:51], s8 offen sc1
    v_mfma_f32_16x16x32_bf16 a[24:27], a[116:119], v[128:131], a[24:27]
    global_load_ushort v18, v16, s[20:21] offset:32
    v_mfma_f32_16x16x32_bf16 a[28:31], a[116:119], v[132:135], a[28:31]
    buffer_load_dwordx4 a[92:95], v6, s[48:51], s8 offen sc1
    v_mfma_f32_16x16x32_bf16 a[32:35], a[116:119], v[208:211], a[32:35]
    global_load_ushort v19, v16, s[20:21] offset:64
    v_mfma_f32_16x16x32_bf16 a[36:39], a[116:119], v[212:215], a[36:39]
    global_load_ushort v20, v16, s[20:21] offset:96
    s_waitcnt vmcnt(22)
    v_mfma_f32_16x16x32_bf16 a[40:43], a[120:123], v[204:207], a[40:43]
    global_load_ushort v21, v16, s[20:21] offset:128
    v_mfma_f32_16x16x32_bf16 a[44:47], a[120:123], v[128:131], a[44:47]
    s_mov_b32 s5, 15990784
    buffer_load_dwordx4 v[32:35], v15, s[48:51], s5 offen sc1
    v_mfma_f32_16x16x32_bf16 a[48:51], a[120:123], v[132:135], a[48:51]
    buffer_load_dwordx4 v[36:39], v15, s[48:51], s5 offen offset:16 sc1
    v_mfma_f32_16x16x32_bf16 a[52:55], a[120:123], v[208:211], a[52:55]
    v_mfma_f32_16x16x32_bf16 a[56:59], a[120:123], v[212:215], a[56:59]
    s_waitcnt vmcnt(24)
    v_mfma_f32_16x16x32_bf16 a[60:63], a[124:127], v[204:207], a[60:63]
    v_mfma_f32_16x16x32_bf16 a[64:67], a[124:127], v[128:131], a[64:67]
    v_mfma_f32_16x16x32_bf16 a[68:71], a[124:127], v[132:135], a[68:71]
    v_mfma_f32_16x16x32_bf16 a[72:75], a[124:127], v[208:211], a[72:75]
    v_mfma_f32_16x16x32_bf16 a[76:79], a[124:127], v[212:215], a[76:79]
    s_waitcnt vmcnt(22)
    v_mfma_f32_16x16x32_bf16 a[0:3], a[128:131], v[136:139], a[0:3]
    v_mfma_f32_16x16x32_bf16 a[4:7], a[128:131], v[140:143], a[4:7]
    s_add_u32 s8, s9, 36864
    buffer_load_dwordx4 a[96:99], v3, s[48:51], s8 offen sc1
    v_mfma_f32_16x16x32_bf16 a[8:11], a[128:131], v[216:219], a[8:11]
    buffer_load_dwordx4 a[100:103], v4, s[48:51], s8 offen sc1
    v_mfma_f32_16x16x32_bf16 a[12:15], a[128:131], v[220:223], a[12:15]
    buffer_load_dwordx4 a[104:107], v5, s[48:51], s8 offen sc1
    v_mfma_f32_16x16x32_bf16 a[16:19], a[128:131], v[144:147], a[16:19]
    buffer_load_dwordx4 a[108:111], v6, s[48:51], s8 offen sc1
    s_waitcnt vmcnt(25)
    v_mfma_f32_16x16x32_bf16 a[20:23], a[132:135], v[136:139], a[20:23]
    v_mfma_f32_16x16x32_bf16 a[24:27], a[132:135], v[140:143], a[24:27]
    v_mfma_f32_16x16x32_bf16 a[28:31], a[132:135], v[216:219], a[28:31]
    v_mfma_f32_16x16x32_bf16 a[32:35], a[132:135], v[220:223], a[32:35]
    v_mfma_f32_16x16x32_bf16 a[36:39], a[132:135], v[144:147], a[36:39]
    s_waitcnt vmcnt(24)
    v_mfma_f32_16x16x32_bf16 a[40:43], a[136:139], v[136:139], a[40:43]
    v_mfma_f32_16x16x32_bf16 a[44:47], a[136:139], v[140:143], a[44:47]
    v_mfma_f32_16x16x32_bf16 a[48:51], a[136:139], v[216:219], a[48:51]
    v_mfma_f32_16x16x32_bf16 a[52:55], a[136:139], v[220:223], a[52:55]
    v_mfma_f32_16x16x32_bf16 a[56:59], a[136:139], v[144:147], a[56:59]
    s_waitcnt vmcnt(23)
    v_mfma_f32_16x16x32_bf16 a[60:63], a[140:143], v[136:139], a[60:63]
    v_mfma_f32_16x16x32_bf16 a[64:67], a[140:143], v[140:143], a[64:67]
    v_mfma_f32_16x16x32_bf16 a[68:71], a[140:143], v[216:219], a[68:71]
    v_mfma_f32_16x16x32_bf16 a[72:75], a[140:143], v[220:223], a[72:75]
    v_mfma_f32_16x16x32_bf16 a[76:79], a[140:143], v[144:147], a[76:79]
    s_waitcnt vmcnt(14)
    v_cmp_ne_u32 vcc, s69, v29
    s_cbranch_vccz L_ok6
    s_mov_b32 s94, 262144
L_rt6:
    s_sleep 1
    s_add_u32 s4, s7, 16060416
    v_and_b32 v29, 15, v1
    v_lshlrev_b32 v29, 2, v29
    buffer_load_dword v29, v29, s[48:51], s4 offen sc1
    s_waitcnt vmcnt(0)
    s_nop 1
    v_cmp_ne_u32 vcc, s69, v29
    s_cbranch_vccz L_ok6
    s_sub_u32 s94, s94, 1
    s_cmp_lg_u32 s94, 0
    s_cbranch_scc1 L_rt6
    s_nop 7
L_ok6:
    v_mfma_f32_16x16x32_bf16 a[0:3], a[144:147], v[148:151], a[0:3]
    ds_read_u16 v56, v25 offset:0
    ds_read_u16 v57, v25 offset:160
    v_mfma_f32_16x16x32_bf16 a[4:7], a[144:147], v[224:227], a[4:7]
    s_add_u32 s8, s10, 0
    buffer_load_dwordx4 a[112:115], v3, s[48:51], s8 offen sc1
    v_mfma_f32_16x16x32_bf16 a[8:11], a[144:147], v[228:231], a[8:11]
    buffer_load_dwordx4 a[116:119], v4, s[48:51], s8 offen sc1
    ds_read_u16 v58, v25 offset:320
    v_mfma_f32_16x16x32_bf16 a[12:15], a[144:147], v[152:155], a[12:15]
    buffer_load_dwordx4 a[120:123], v5, s[48:51], s8 offen sc1
    ds_read_u16 v59, v25 offset:480
    v_mfma_f32_16x16x32_bf16 a[16:19], a[144:147], v[156:159], a[16:19]
    buffer_load_dwordx4 a[124:127], v6, s[48:51], s8 offen sc1
    ds_read_u16 v60, v25 offset:32
    v_mfma_f32_16x16x32_bf16 a[20:23], a[148:151], v[148:151], a[20:23]
    ds_read_u16 v61, v25 offset:192
    ds_read_u16 v62, v25 offset:352
    v_mfma_f32_16x16x32_bf16 a[24:27], a[148:151], v[224:227], a[24:27]
    ds_read_u16 v63, v25 offset:512
    ds_read_u16 v64, v25 offset:64
    v_mfma_f32_16x16x32_bf16 a[28:31], a[148:151], v[228:231], a[28:31]
    ds_read_u16 v65, v25 offset:224
    ds_read_u16 v66, v25 offset:384
    v_mfma_f32_16x16x32_bf16 a[32:35], a[148:151], v[152:155], a[32:35]
    ds_read_u16 v67, v25 offset:544
    ds_read_u16 v68, v25 offset:96
    v_mfma_f32_16x16x32_bf16 a[36:39], a[148:151], v[156:159], a[36:39]
    ds_read_u16 v69, v25 offset:256
    ds_read_u16 v70, v25 offset:416
    v_mfma_f32_16x16x32_bf16 a[40:43], a[152:155], v[148:151], a[40:43]
    ds_read_u16 v71, v25 offset:576
    ds_read_u16 v72, v25 offset:128
    v_mfma_f32_16x16x32_bf16 a[44:47], a[152:155], v[224:227], a[44:47]
    ds_read_u16 v73, v25 offset:288
    ds_read_u16 v74, v25 offset:448
    v_mfma_f32_16x16x32_bf16 a[48:51], a[152:155], v[228:231], a[48:51]
    ds_read_u16 v75, v25 offset:608
    s_waitcnt vmcnt(16)
    v_lshlrev_b32 v17, 16, v17
    v_mfma_f32_16x16x32_bf16 a[52:55], a[152:155], v[152:155], a[52:55]
    s_waitcnt vmcnt(14)
    v_lshlrev_b32 v18, 16, v18
    s_waitcnt vmcnt(12)
    v_lshlrev_b32 v19, 16, v19
    v_mfma_f32_16x16x32_bf16 a[56:59], a[152:155], v[156:159], a[56:59]
    s_waitcnt vmcnt(11)
    v_lshlrev_b32 v20, 16, v20
    s_waitcnt vmcnt(10)
    v_lshlrev_b32 v21, 16, v21
    v_mfma_f32_16x16x32_bf16 a[60:63], a[156:159], v[148:151], a[60:63]
    s_waitcnt lgkmcnt(15)
    v_lshlrev_b32 v56, 16, v56
    v_lshlrev_b32 v57, 16, v57
    v_mfma_f32_16x16x32_bf16 a[64:67], a[156:159], v[224:227], a[64:67]
    v_lshlrev_b32 v58, 16, v58
    v_lshlrev_b32 v59, 16, v59
    v_mfma_f32_16x16x32_bf16 a[68:71], a[156:159], v[228:231], a[68:71]
    v_lshlrev_b32 v60, 16, v60
    s_waitcnt lgkmcnt(14)
    v_lshlrev_b32 v61, 16, v61
    v_mfma_f32_16x16x32_bf16 a[72:75], a[156:159], v[152:155], a[72:75]
    s_waitcnt lgkmcnt(13)
    v_lshlrev_b32 v62, 16, v62
    s_waitcnt lgkmcnt(12)
    v_lshlrev_b32 v63, 16, v63
    v_mfma_f32_16x16x32_bf16 a[76:79], a[156:159], v[156:159], a[76:79]
    s_waitcnt lgkmcnt(11)
    v_lshlrev_b32 v64, 16, v64
    s_waitcnt lgkmcnt(10)
    v_lshlrev_b32 v65, 16, v65
    v_mfma_f32_16x16x32_bf16 a[0:3], a[80:83], v[232:235], a[0:3]
    s_waitcnt lgkmcnt(9)
    v_lshlrev_b32 v66, 16, v66
    s_waitcnt lgkmcnt(8)
    v_lshlrev_b32 v67, 16, v67
    v_mfma_f32_16x16x32_bf16 a[4:7], a[80:83], v[236:239], a[4:7]
    s_add_u32 s8, s10, 4096
    buffer_load_dwordx4 a[128:131], v3, s[48:51], s8 offen sc1
    v_mfma_f32_16x16x32_bf16 a[8:11], a[80:83], v[160:163], a[8:11]
    buffer_load_dwordx4 a[132:135], v4, s[48:51], s8 offen sc1
    v_mfma_f32_16x16x32_bf16 a[12:15], a[80:83], v[164:167], a[12:15]
    buffer_load_dwordx4 a[136:139], v5, s[48:51], s8 offen sc1
    v_mfma_f32_16x16x32_bf16 a[16:19], a[80:83], v[240:243], a[16:19]
    buffer_load_dwordx4 a[140:143], v6, s[48:51], s8 offen sc1
    v_mfma_f32_16x16x32_bf16 a[20:23], a[84:87], v[232:235], a[20:23]
    s_waitcnt lgkmcnt(7)
    v_lshlrev_b32 v68, 16, v68
    s_waitcnt lgkmcnt(6)
    v_lshlrev_b32 v69, 16, v69
    v_mfma_f32_16x16x32_bf16 a[24:27], a[84:87], v[236:239], a[24:27]
    s_waitcnt lgkmcnt(5)
    v_lshlrev_b32 v70, 16, v70
    s_waitcnt lgkmcnt(4)
    v_lshlrev_b32 v71, 16, v71
    v_mfma_f32_16x16x32_bf16 a[28:31], a[84:87], v[160:163], a[28:31]
    s_waitcnt lgkmcnt(3)
    v_lshlrev_b32 v72, 16, v72
    s_waitcnt lgkmcnt(2)
    v_lshlrev_b32 v73, 16, v73
    v_mfma_f32_16x16x32_bf16 a[32:35], a[84:87], v[164:167], a[32:35]
    s_waitcnt lgkmcnt(1)
    v_lshlrev_b32 v74, 16, v74
    s_waitcnt lgkmcnt(0)
    v_lshlrev_b32 v75, 16, v75
    v_mfma_f32_16x16x32_bf16 a[36:39], a[84:87], v[240:243], a[36:39]
    s_waitcnt vmcnt(13)
    v_fma_f32 v96, v56, v32, v33
    v_fma_f32 v97, v57, v34, v35
    v_mfma_f32_16x16x32_bf16 a[40:43], a[88:91], v[232:235], a[40:43]
    s_waitcnt vmcnt(12)
    v_fma_f32 v98, v58, v36, v37
    v_fma_f32 v99, v59, v38, v39
    v_mfma_f32_16x16x32_bf16 a[44:47], a[88:91], v[236:239], a[44:47]
    s_add_u32 s11, s13, 20480
    buffer_load_dwordx4 a[196:199], v2, s[48:51], s11 offen offset:0 sc1
    v_mfma_f32_16x16x32_bf16 a[48:51], a[88:91], v[160:163], a[48:51]
    v_mul_f32 v96, v96, v17
    v_mul_f32 v97, v97, v17
    v_mfma_f32_16x16x32_bf16 a[52:55], a[88:91], v[164:167], a[52:55]
    v_mul_f32 v98, v98, v17
    v_mul_f32 v99, v99, v17
    v_mfma_f32_16x16x32_bf16 a[56:59], a[88:91], v[240:243], a[56:59]
    v_fma_f32 v100, v60, v32, v33
    v_fma_f32 v101, v61, v34, v35
    v_mfma_f32_16x16x32_bf16 a[60:63], a[92:95], v[232:235], a[60:63]
    buffer_load_dwordx4 a[200:203], v2, s[48:51], s11 offen offset:1024 sc1
    v_mfma_f32_16x16x32_bf16 a[64:67], a[92:95], v[236:239], a[64:67]
    v_fma_f32 v102, v62, v36, v37
    v_fma_f32 v103, v63, v38, v39
    v_mfma_f32_16x16x32_bf16 a[68:71], a[92:95], v[160:163], a[68:71]
    v_mul_f32 v100, v100, v18
    v_mul_f32 v101, v101, v18
    v_mfma_f32_16x16x32_bf16 a[72:75], a[92:95], v[164:167], a[72:75]
    v_mul_f32 v102, v102, v18
    v_mul_f32 v103, v103, v18
    v_mfma_f32_16x16x32_bf16 a[76:79], a[92:95], v[240:243], a[76:79]
    buffer_load_dwordx4 a[204:207], v2, s[48:51], s11 offen offset:2048 sc1
    s_waitcnt vmcnt(14)
    v_mfma_f32_16x16x32_bf16 a[0:3], a[96:99], v[244:247], a[0:3]
    v_fma_f32 v104, v64, v32, v33
    v_fma_f32 v105, v65, v34, v35
    v_mfma_f32_16x16x32_bf16 a[4:7], a[96:99], v[168:171], a[4:7]
    s_add_u32 s8, s10, 8192
    buffer_load_dwordx4 a[144:147], v3, s[48:51], s8 offen sc1
    v_mfma_f32_16x16x32_bf16 a[8:11], a[96:99], v[172:175], a[8:11]
    buffer_load_dwordx4 a[148:151], v4, s[48:51], s8 offen sc1
    v_mfma_f32_16x16x32_bf16 a[12:15], a[96:99], v[248:251], a[12:15]
    buffer_load_dwordx4 a[152:155], v5, s[48:51], s8 offen sc1
    v_mfma_f32_16x16x32_bf16 a[16:19], a[96:99], v[252:255], a[16:19]
    buffer_load_dwordx4 a[156:159], v6, s[48:51], s8 offen sc1
    v_fma_f32 v106, v66, v36, v37
    s_waitcnt vmcnt(17)
    v_mfma_f32_16x16x32_bf16 a[20:23], a[100:103], v[244:247], a[20:23]
    v_fma_f32 v107, v67, v38, v39
    v_mul_f32 v104, v104, v19
    v_mfma_f32_16x16x32_bf16 a[24:27], a[100:103], v[168:171], a[24:27]
    v_mul_f32 v105, v105, v19
    v_mul_f32 v106, v106, v19
    v_mfma_f32_16x16x32_bf16 a[28:31], a[100:103], v[172:175], a[28:31]
    v_mul_f32 v107, v107, v19
    v_fma_f32 v108, v68, v32, v33
    v_mfma_f32_16x16x32_bf16 a[32:35], a[100:103], v[248:251], a[32:35]
    buffer_load_dwordx4 a[208:211], v2, s[48:51], s11 offen offset:3072 sc1
    v_fma_f32 v109, v69, v34, v35
    v_fma_f32 v110, v70, v36, v37
    v_mfma_f32_16x16x32_bf16 a[36:39], a[100:103], v[252:255], a[36:39]
    v_fma_f32 v111, v71, v38, v39
    v_mul_f32 v108, v108, v20
    s_waitcnt vmcnt(17)
    v_mfma_f32_16x16x32_bf16 a[40:43], a[104:107], v[244:247], a[40:43]
    v_mul_f32 v109, v109, v20
    v_mul_f32 v110, v110, v20
    v_mfma_f32_16x16x32_bf16 a[44:47], a[104:107], v[168:171], a[44:47]
    v_mul_f32 v111, v111, v20
    v_fma_f32 v112, v72, v32, v33
    v_mfma_f32_16x16x32_bf16 a[48:51], a[104:107], v[172:175], a[48:51]
    buffer_load_dwordx4 a[212:215], v12, s[48:51], s11 offen offset:0 sc1
    v_fma_f32 v113, v73, v34, v35
    v_mfma_f32_16x16x32_bf16 a[52:55], a[104:107], v[248:251], a[52:55]
    v_fma_f32 v114, v74, v36, v37
    v_fma_f32 v115, v75, v38, v39
    v_mfma_f32_16x16x32_bf16 a[56:59], a[104:107], v[252:255], a[56:59]
    v_mul_f32 v112, v112, v21
    v_mul_f32 v113, v113, v21
    s_waitcnt vmcnt(17)
    v_mfma_f32_16x16x32_bf16 a[60:63], a[108:111], v[244:247], a[60:63]
    v_mul_f32 v114, v114, v21
    v_mul_f32 v115, v115, v21
    ds_read_b128 v[176:179], v26 offset:0
    ds_read_b128 v[180:183], v26 offset:1024
    ds_read_b128 v[184:187], v26 offset:2048
    ds_read_b128 v[188:191], v26 offset:3072
    ds_read_b128 v[192:195], v26 offset:4096
    v_mfma_f32_16x16x32_bf16 a[64:67], a[108:111], v[168:171], a[64:67]
    s_add_u32 s11, s13, 25600
    buffer_load_dwordx4 a[216:219], v2, s[48:51], s11 offen offset:0 sc1
    v_mfma_f32_16x16x32_bf16 a[68:71], a[108:111], v[172:175], a[68:71]
    ds_read_b128 v[196:199], v26 offset:5120
    ds_read_b128 v[200:203], v26 offset:6144
    v_mfma_f32_16x16x32_bf16 a[72:75], a[108:111], v[248:251], a[72:75]
    ds_read_b128 v[204:207], v26 offset:7168
    ds_read_b128 v[208:211], v26 offset:8192
    v_mfma_f32_16x16x32_bf16 a[76:79], a[108:111], v[252:255], a[76:79]
    buffer_load_dwordx4 a[220:223], v2, s[48:51], s11 offen offset:1024 sc1
    s_waitcnt vmcnt(18) lgkmcnt(8)
    v_mfma_f32_16x16x32_bf16 v[96:99], a[112:115], v[176:179], v[96:99]
    ds_read_b128 v[212:215], v26 offset:9216
    ds_read_b128 v[216:219], v26 offset:10240
    s_waitcnt lgkmcnt(9)
    v_mfma_f32_16x16x32_bf16 v[100:103], a[112:115], v[180:183], v[100:103]
    s_add_u32 s8, s10, 12288
    buffer_load_dwordx4 a[80:83], v3, s[48:51], s8 offen sc1
    s_waitcnt lgkmcnt(8)
    v_mfma_f32_16x16x32_bf16 v[104:107], a[112:115], v[184:187], v[104:107]
    buffer_load_dwordx4 a[84:87], v4, s[48:51], s8 offen sc1
    s_waitcnt lgkmcnt(7)
    v_mfma_f32_16x16x32_bf16 v[108:111], a[112:115], v[188:191], v[108:111]
    buffer_load_dwordx4 a[88:91], v5, s[48:51], s8 offen sc1
    s_waitcnt lgkmcnt(6)
    v_mfma_f32_16x16x32_bf16 v[112:115], a[112:115], v[192:195], v[112:115]
    buffer_load_dwordx4 a[92:95], v6, s[48:51], s8 offen sc1
    s_waitcnt vmcnt(21)
    v_mfma_f32_16x16x32_bf16 v[116:119], a[116:119], v[176:179], 0
    ds_read_b128 v[220:223], v26 offset:11264
    ds_read_b128 v[224:227], v26 offset:12288
    v_mfma_f32_16x16x32_bf16 v[120:123], a[116:119], v[180:183], 0
    ds_read_b128 v[228:231], v26 offset:13312
    ds_read_b128 v[232:235], v26 offset:14336
    v_mfma_f32_16x16x32_bf16 v[124:127], a[116:119], v[184:187], 0
    ds_read_b128 v[236:239], v26 offset:15360
    ds_read_b128 v[240:243], v26 offset:16384
    v_mfma_f32_16x16x32_bf16 v[128:131], a[116:119], v[188:191], 0
    buffer_load_dwordx4 a[224:227], v2, s[48:51], s11 offen offset:2048 sc1
    v_mfma_f32_16x16x32_bf16 v[132:135], a[116:119], v[192:195], 0
    ds_read_b128 v[244:247], v26 offset:17408
    ds_read_b128 v[248:251], v26 offset:18432
    s_waitcnt vmcnt(21)
    v_mfma_f32_16x16x32_bf16 v[136:139], a[120:123], v[176:179], 0
    ds_read_b128 v[252:255], v26 offset:19456
    ds_write_b128 v7, a[20:23] offset:0
    v_mfma_f32_16x16x32_bf16 v[140:143], a[120:123], v[180:183], 0
    v_accvgpr_read_b32 v76, a0
    ds_write_b128 v7, a[24:27] offset:1024
    v_mfma_f32_16x16x32_bf16 v[144:147], a[120:123], v[184:187], 0
    buffer_load_dwordx4 a[228:231], v2, s[48:51], s11 offen offset:3072 sc1
    v_mfma_f32_16x16x32_bf16 v[148:151], a[120:123], v[188:191], 0
    v_accvgpr_read_b32 v77, a1
    ds_write_b128 v7, a[28:31] offset:2048
    v_mfma_f32_16x16x32_bf16 v[152:155], a[120:123], v[192:195], 0
    v_accvgpr_read_b32 v78, a2
    v_accvgpr_read_b32 v79, a3
    s_waitcnt vmcnt(21)
    v_mfma_f32_16x16x32_bf16 v[156:159], a[124:127], v[176:179], 0
    ds_write_b128 v7, a[32:35] offset:3072
    v_accvgpr_read_b32 v80, a4
    v_mfma_f32_16x16x32_bf16 v[160:163], a[124:127], v[180:183], 0
    buffer_load_dwordx4 a[232:235], v12, s[48:51], s11 offen offset:0 sc1
    v_mfma_f32_16x16x32_bf16 v[164:167], a[124:127], v[184:187], 0
    ds_write_b128 v7, a[36:39] offset:4096
    v_accvgpr_read_b32 v81, a5
    v_mfma_f32_16x16x32_bf16 v[168:171], a[124:127], v[188:191], 0
    ds_write_b128 v8, a[40:43] offset:0
    v_accvgpr_read_b32 v82, a6
    v_mfma_f32_16x16x32_bf16 v[172:175], a[124:127], v[192:195], 0
    v_accvgpr_read_b32 v83, a7
    ds_write_b128 v8, a[44:47] offset:1024
    s_waitcnt vmcnt(21) lgkmcnt(15)
    v_mfma_f32_16x16x32_bf16 v[96:99], a[128:131], v[196:199], v[96:99]
    v_accvgpr_read_b32 v84, a8
    ds_write_b128 v8, a[48:51] offset:2048
    v_mfma_f32_16x16x32_bf16 v[100:103], a[128:131], v[200:203], v[100:103]
    s_add_u32 s8, s10, 16384
    buffer_load_dwordx4 a[96:99], v3, s[48:51], s8 offen sc1
    v_mfma_f32_16x16x32_bf16 v[104:107], a[128:131], v[204:207], v[104:107]
    buffer_load_dwordx4 a[100:103], v4, s[48:51], s8 offen sc1
    v_mfma_f32_16x16x32_bf16 v[108:111], a[128:131], v[208:211], v[108:111]
    buffer_load_dwordx4 a[104:107], v5, s[48:51], s8 offen sc1
    v_mfma_f32_16x16x32_bf16 v[112:115], a[128:131], v[212:215], v[112:115]
    buffer_load_dwordx4 a[108:111], v6, s[48:51], s8 offen sc1
    s_waitcnt vmcnt(24)
    v_mfma_f32_16x16x32_bf16 v[116:119], a[132:135], v[196:199], v[116:119]
    v_accvgpr_read_b32 v85, a9
    ds_write_b128 v8, a[52:55] offset:3072
    v_mfma_f32_16x16x32_bf16 v[120:123], a[132:135], v[200:203], v[120:123]
    v_accvgpr_read_b32 v86, a10
    v_accvgpr_read_b32 v87, a11
    v_mfma_f32_16x16x32_bf16 v[124:127], a[132:135], v[204:207], v[124:127]
    ds_write_b128 v8, a[56:59] offset:4096
    v_accvgpr_read_b32 v88, a12
    v_mfma_f32_16x16x32_bf16 v[128:131], a[132:135], v[208:211], v[128:131]
    s_add_u32 s11, s13, 30720
    buffer_load_dwordx4 a[236:239], v2, s[48:51], s11 offen offset:0 sc1
    v_mfma_f32_16x16x32_bf16 v[132:135], a[132:135], v[212:215], v[132:135]
    ds_write_b128 v9, a[60:63] offset:0
    v_accvgpr_read_b32 v89, a13
    s_waitcnt vmcnt(24)
    v_mfma_f32_16x16x32_bf16 v[136:139], a[136:139], v[196:199], v[136:139]
    ds_write_b128 v9, a[64:67] offset:1024
    v_accvgpr_read_b32 v90, a14
    v_mfma_f32_16x16x32_bf16 v[140:143], a[136:139], v[200:203], v[140:143]
    v_accvgpr_read_b32 v91, a15
    ds_write_b128 v9, a[68:71] offset:2048
    v_mfma_f32_16x16x32_bf16 v[144:147], a[136:139], v[204:207], v[144:147]
    buffer_load_dwordx4 a[240:243], v2, s[48:51], s11 offen offset:1024 sc1
    v_mfma_f32_16x16x32_bf16 v[148:151], a[136:139], v[208:211], v[148:151]
    v_accvgpr_read_b32 v92, a16
    ds_write_b128 v9, a[72:75] offset:3072
    v_mfma_f32_16x16x32_bf16 v[152:155], a[136:139], v[212:215], v[152:155]
    v_accvgpr_read_b32 v93, a17
    ds_write_b128 v9, a[76:79] offset:4096
    s_waitcnt vmcnt(24)
    v_mfma_f32_16x16x32_bf16 v[156:159], a[140:143], v[196:199], v[156:159]
    v_accvgpr_read_b32 v94, a18
    v_accvgpr_read_b32 v95, a19
    v_mfma_f32_16x16x32_bf16 v[160:163], a[140:143], v[200:203], v[160:163]
    buffer_load_dwordx4 a[244:247], v2, s[48:51], s11 offen offset:2048 sc1
    v_mfma_f32_16x16x32_bf16 v[164:167], a[140:143], v[204:207], v[164:167]
    v_mfma_f32_16x16x32_bf16 v[168:171], a[140:143], v[208:211], v[168:171]
    v_mfma_f32_16x16x32_bf16 v[172:175], a[140:143], v[212:215], v[172:175]
    s_waitcnt vmcnt(21)
    v_mfma_f32_16x16x32_bf16 v[96:99], a[144:147], v[216:219], v[96:99]
    v_mfma_f32_16x16x32_bf16 v[100:103], a[144:147], v[220:223], v[100:103]
    s_add_u32 s8, s10, 20480
    buffer_load_dwordx4 a[112:115], v3, s[48:51], s8 offen sc1
    s_waitcnt lgkmcnt(15)
    v_mfma_f32_16x16x32_bf16 v[104:107], a[144:147], v[224:227], v[104:107]
    buffer_load_dwordx4 a[116:119], v4, s[48:51], s8 offen sc1
    v_mfma_f32_16x16x32_bf16 v[108:111], a[144:147], v[228:231], v[108:111]
    buffer_load_dwordx4 a[120:123], v5, s[48:51], s8 offen sc1
    v_mfma_f32_16x16x32_bf16 v[112:115], a[144:147], v[232:235], v[112:115]
    buffer_load_dwordx4 a[124:127], v6, s[48:51], s8 offen sc1
    s_waitcnt vmcnt(24)
    v_mfma_f32_16x16x32_bf16 v[116:119], a[148:151], v[216:219], v[116:119]
    v_mfma_f32_16x16x32_bf16 v[120:123], a[148:151], v[220:223], v[120:123]
    v_mfma_f32_16x16x32_bf16 v[124:127], a[148:151], v[224:227], v[124:127]
    v_mfma_f32_16x16x32_bf16 v[128:131], a[148:151], v[228:231], v[128:131]
    buffer_load_dwordx4 a[248:251], v2, s[48:51], s11 offen offset:3072 sc1
    v_mfma_f32_16x16x32_bf16 v[132:135], a[148:151], v[232:235], v[132:135]
    s_waitcnt vmcnt(24)
    v_mfma_f32_16x16x32_bf16 v[136:139], a[152:155], v[216:219], v[136:139]
    v_mfma_f32_16x16x32_bf16 v[140:143], a[152:155], v[220:223], v[140:143]
    v_mfma_f32_16x16x32_bf16 v[144:147], a[152:155], v[224:227], v[144:147]
    buffer_load_dwordx4 a[252:255], v12, s[48:51], s11 offen offset:0 sc1
    v_mfma_f32_16x16x32_bf16 v[148:151], a[152:155], v[228:231], v[148:151]
    v_mfma_f32_16x16x32_bf16 v[152:155], a[152:155], v[232:235], v[152:155]
    s_waitcnt vmcnt(24)
    v_mfma_f32_16x16x32_bf16 v[156:159], a[156:159], v[216:219], v[156:159]
    v_mfma_f32_16x16x32_bf16 v[160:163], a[156:159], v[220:223], v[160:163]
    s_add_u32 s11, s13, 35840
    buffer_load_dwordx4 a[160:163], v2, s[48:51], s11 offen offset:0 sc1
    v_mfma_f32_16x16x32_bf16 v[164:167], a[156:159], v[224:227], v[164:167]
    v_mfma_f32_16x16x32_bf16 v[168:171], a[156:159], v[228:231], v[168:171]
    v_mfma_f32_16x16x32_bf16 v[172:175], a[156:159], v[232:235], v[172:175]
    s_waitcnt lgkmcnt(0)
    s_barrier
    s_waitcnt vmcnt(20)
    v_mfma_f32_16x16x32_bf16 v[96:99], a[80:83], v[236:239], v[96:99]
    ds_read_b128 v[32:35], v11 offset:0
    ds_read_b128 v[36:39], v11 offset:5120
    v_mfma_f32_16x16x32_bf16 v[100:103], a[80:83], v[240:243], v[100:103]
    s_add_u32 s8, s10, 24576
    buffer_load_dwordx4 a[128:131], v3, s[48:51], s8 offen sc1
    ds_read_b128 v[40:43], v11 offset:10240
    v_mfma_f32_16x16x32_bf16 v[104:107], a[80:83], v[244:247], v[104:107]
    buffer_load_dwordx4 a[132:135], v4, s[48:51], s8 offen sc1
    v_mfma_f32_16x16x32_bf16 v[108:111], a[80:83], v[248:251], v[108:111]
    buffer_load_dwordx4 a[136:139], v5, s[48:51], s8 offen sc1
    v_mfma_f32_16x16x32_bf16 v[112:115], a[80:83], v[252:255], v[112:115]
    buffer_load_dwordx4 a[140:143], v6, s[48:51], s8 offen sc1
    s_waitcnt lgkmcnt(2)
    v_add_f32 v76, v76, v32
    v_add_f32 v77, v77, v33
    s_waitcnt vmcnt(23)
    v_mfma_f32_16x16x32_bf16 v[116:119], a[84:87], v[236:239], v[116:119]
    v_add_f32 v78, v78, v34
    v_add_f32 v79, v79, v35
    s_waitcnt lgkmcnt(0)
    v_add_f32 v36, v36, v40
    v_mfma_f32_16x16x32_bf16 v[120:123], a[84:87], v[240:243], v[120:123]
    v_add_f32 v37, v37, v41
    v_add_f32 v38, v38, v42
    v_add_f32 v39, v39, v43
    v_mfma_f32_16x16x32_bf16 v[124:127], a[84:87], v[244:247], v[124:127]
    v_add_f32 v76, v76, v36
    v_add_f32 v77, v77, v37
    v_add_f32 v78, v78, v38
    v_mfma_f32_16x16x32_bf16 v[128:131], a[84:87], v[248:251], v[128:131]
    v_add_f32 v79, v79, v39
    v_mul_f32 v32, 0xbfb8aa3b, v76
    v_mul_f32 v33, 0xbfb8aa3b, v77
    v_mfma_f32_16x16x32_bf16 v[132:135], a[84:87], v[252:255], v[132:135]
    buffer_load_dwordx4 a[164:167], v2, s[48:51], s11 offen offset:1024 sc1
    v_mul_f32 v34, 0xbfb8aa3b, v78
    v_mul_f32 v35, 0xbfb8aa3b, v79
    s_waitcnt vmcnt(23)
    v_mfma_f32_16x16x32_bf16 v[136:139], a[88:91], v[236:239], v[136:139]
    v_exp_f32 v32, v32
    v_mfma_f32_16x16x32_bf16 v[140:143], a[88:91], v[240:243], v[140:143]
    v_exp_f32 v33, v33
    v_exp_f32 v34, v34
    v_mfma_f32_16x16x32_bf16 v[144:147], a[88:91], v[244:247], v[144:147]
    buffer_load_dwordx4 a[168:171], v2, s[48:51], s11 offen offset:2048 sc1
    v_exp_f32 v35, v35
    v_add_f32 v32, 1.0, v32
    v_mfma_f32_16x16x32_bf16 v[148:151], a[88:91], v[248:251], v[148:151]
    v_add_f32 v33, 1.0, v33
    v_add_f32 v34, 1.0, v34
    v_add_f32 v35, 1.0, v35
    v_mfma_f32_16x16x32_bf16 v[152:155], a[88:91], v[252:255], v[152:155]
    v_rcp_f32 v32, v32
    s_waitcnt vmcnt(23)
    v_mfma_f32_16x16x32_bf16 v[156:159], a[92:95], v[236:239], v[156:159]
    buffer_load_dwordx4 a[172:175], v2, s[48:51], s11 offen offset:3072 sc1
    v_rcp_f32 v33, v33
    v_rcp_f32 v34, v34
    v_mfma_f32_16x16x32_bf16 v[160:163], a[92:95], v[240:243], v[160:163]
    v_rcp_f32 v35, v35
    v_mfma_f32_16x16x32_bf16 v[164:167], a[92:95], v[244:247], v[164:167]
    v_mul_f32 v76, v76, v32
    v_mul_f32 v77, v77, v33
    v_mul_f32 v78, v78, v34
    v_mfma_f32_16x16x32_bf16 v[168:171], a[92:95], v[248:251], v[168:171]
    buffer_load_dwordx4 a[176:179], v12, s[48:51], s11 offen offset:0 sc1
    v_mul_f32 v79, v79, v35
    ds_read_b128 v[44:47], v11 offset:1024
    v_mfma_f32_16x16x32_bf16 v[172:175], a[92:95], v[252:255], v[172:175]
    ds_read_b128 v[48:51], v11 offset:6144
    ds_read_b128 v[52:55], v11 offset:11264
    s_waitcnt vmcnt(21)
    v_mfma_f32_16x16x32_bf16 v[96:99], a[96:99], a[196:199], v[96:99]
    v_mfma_f32_16x16x32_bf16 v[100:103], a[96:99], a[200:203], v[100:103]
    s_add_u32 s8, s10, 28672
    buffer_load_dwordx4 a[144:147], v3, s[48:51], s8 offen sc1
    v_mfma_f32_16x16x32_bf16 v[104:107], a[96:99], a[204:207], v[104:107]
    buffer_load_dwordx4 a[148:151], v4, s[48:51], s8 offen sc1
    v_mfma_f32_16x16x32_bf16 v[108:111], a[96:99], a[208:211], v[108:111]
    buffer_load_dwordx4 a[152:155], v5, s[48:51], s8 offen sc1
    s_waitcnt lgkmcnt(2)
    v_add_f32 v80, v80, v44
    v_add_f32 v81, v81, v45
    v_mfma_f32_16x16x32_bf16 v[112:115], a[96:99], a[212:215], v[112:115]
    buffer_load_dwordx4 a[156:159], v6, s[48:51], s8 offen sc1
    v_add_f32 v82, v82, v46
    v_add_f32 v83, v83, v47
    s_waitcnt lgkmcnt(0)
    v_add_f32 v48, v48, v52
    s_waitcnt vmcnt(24)
    v_mfma_f32_16x16x32_bf16 v[116:119], a[100:103], a[196:199], v[116:119]
    v_add_f32 v49, v49, v53
    v_add_f32 v50, v50, v54
    v_add_f32 v51, v51, v55
    v_mfma_f32_16x16x32_bf16 v[120:123], a[100:103], a[200:203], v[120:123]
    v_add_f32 v80, v80, v48
    v_add_f32 v81, v81, v49
    v_add_f32 v82, v82, v50
    v_mfma_f32_16x16x32_bf16 v[124:127], a[100:103], a[204:207], v[124:127]
    s_add_u32 s11, s13, 40960
    buffer_load_dwordx4 v[176:179], v2, s[48:51], s11 offen offset:0 sc1
    v_add_f32 v83, v83, v51
    v_mul_f32 v44, 0xbfb8aa3b, v80
    v_mfma_f32_16x16x32_bf16 v[128:131], a[100:103], a[208:211], v[128:131]
    v_mul_f32 v45, 0xbfb8aa3b, v81
    v_mul_f32 v46, 0xbfb8aa3b, v82
    v_mul_f32 v47, 0xbfb8aa3b, v83
    v_mfma_f32_16x16x32_bf16 v[132:135], a[100:103], a[212:215], v[132:135]
    v_exp_f32 v44, v44
    s_waitcnt vmcnt(24)
    v_mfma_f32_16x16x32_bf16 v[136:139], a[104:107], a[196:199], v[136:139]
    buffer_load_dwordx4 v[180:183], v2, s[48:51], s11 offen offset:1024 sc1
    v_exp_f32 v45, v45
    v_exp_f32 v46, v46
    v_mfma_f32_16x16x32_bf16 v[140:143], a[104:107], a[200:203], v[140:143]
    v_exp_f32 v47, v47
    v_add_f32 v44, 1.0, v44
    v_mfma_f32_16x16x32_bf16 v[144:147], a[104:107], a[204:207], v[144:147]
    v_add_f32 v45, 1.0, v45
    v_add_f32 v46, 1.0, v46
    v_add_f32 v47, 1.0, v47
    v_mfma_f32_16x16x32_bf16 v[148:151], a[104:107], a[208:211], v[148:151]
    buffer_load_dwordx4 v[184:187], v2, s[48:51], s11 offen offset:2048 sc1
    v_rcp_f32 v44, v44
    v_mfma_f32_16x16x32_bf16 v[152:155], a[104:107], a[212:215], v[152:155]
    v_rcp_f32 v45, v45
    s_waitcnt vmcnt(25)
    v_mfma_f32_16x16x32_bf16 v[156:159], a[108:111], a[196:199], v[156:159]
    v_rcp_f32 v46, v46
    v_rcp_f32 v47, v47
    v_mfma_f32_16x16x32_bf16 v[160:163], a[108:111], a[200:203], v[160:163]
    buffer_load_dwordx4 v[188:191], v2, s[48:51], s11 offen offset:3072 sc1
    v_mul_f32 v80, v80, v44
    v_mul_f32 v81, v81, v45
    v_mul_f32 v82, v82, v46
    v_mfma_f32_16x16x32_bf16 v[164:167], a[108:111], a[204:207], v[164:167]
    v_mul_f32 v83, v83, v47
    ds_read_b128 v[32:35], v11 offset:2048
    v_mfma_f32_16x16x32_bf16 v[168:171], a[108:111], a[208:211], v[168:171]
    ds_read_b128 v[36:39], v11 offset:7168
    ds_read_b128 v[40:43], v11 offset:12288
    v_mfma_f32_16x16x32_bf16 v[172:175], a[108:111], a[212:215], v[172:175]
    s_waitcnt vmcnt(22)
    v_mfma_f32_16x16x32_bf16 v[96:99], a[112:115], a[216:219], v[96:99]
    v_mfma_f32_16x16x32_bf16 v[100:103], a[112:115], a[220:223], v[100:103]
    buffer_load_dwordx4 v[192:195], v12, s[48:51], s11 offen offset:0 sc1
    v_mfma_f32_16x16x32_bf16 v[104:107], a[112:115], a[224:227], v[104:107]
    s_add_u32 s8, s10, 32768
    buffer_load_dwordx4 a[80:83], v3, s[48:51], s8 offen sc1
    s_waitcnt lgkmcnt(2)
    v_add_f32 v84, v84, v32
    v_add_f32 v85, v85, v33
    v_mfma_f32_16x16x32_bf16 v[108:111], a[112:115], a[228:231], v[108:111]
    buffer_load_dwordx4 a[84:87], v4, s[48:51], s8 offen sc1
    v_add_f32 v86, v86, v34
    v_add_f32 v87, v87, v35
    s_waitcnt lgkmcnt(0)
    v_add_f32 v36, v36, v40
    v_mfma_f32_16x16x32_bf16 v[112:115], a[112:115], a[232:235], v[112:115]
    buffer_load_dwordx4 a[88:91], v5, s[48:51], s8 offen sc1
    v_add_f32 v37, v37, v41
    v_add_f32 v38, v38, v42
    s_waitcnt vmcnt(25)
    v_mfma_f32_16x16x32_bf16 v[116:119], a[116:119], a[216:219], v[116:119]
    buffer_load_dwordx4 a[92:95], v6, s[48:51], s8 offen sc1
    v_add_f32 v39, v39, v43
    v_add_f32 v84, v84, v36
    v_add_f32 v85, v85, v37
    v_mfma_f32_16x16x32_bf16 v[120:123], a[116:119], a[220:223], v[120:123]
    v_add_f32 v86, v86, v38
    v_add_f32 v87, v87, v39
    v_mul_f32 v32, 0xbfb8aa3b, v84
    v_mfma_f32_16x16x32_bf16 v[124:127], a[116:119], a[224:227], v[124:127]
    v_mul_f32 v33, 0xbfb8aa3b, v85
    v_mul_f32 v34, 0xbfb8aa3b, v86
    v_mul_f32 v35, 0xbfb8aa3b, v87
    v_mfma_f32_16x16x32_bf16 v[128:131], a[116:119], a[228:231], v[128:131]
    s_add_u32 s11, s13, 46080
    buffer_load_dwordx4 v[196:199], v2, s[48:51], s11 offen offset:0 sc1
    v_exp_f32 v32, v32
    v_mfma_f32_16x16x32_bf16 v[132:135], a[116:119], a[232:235], v[132:135]
    v_exp_f32 v33, v33
    v_exp_f32 v34, v34
    s_waitcnt vmcnt(26)
    v_mfma_f32_16x16x32_bf16 v[136:139], a[120:123], a[216:219], v[136:139]
    v_exp_f32 v35, v35
    v_mfma_f32_16x16x32_bf16 v[140:143], a[120:123], a[220:223], v[140:143]
    buffer_load_dwordx4 v[200:203], v2, s[48:51], s11 offen offset:1024 sc1
    v_add_f32 v32, 1.0, v32
    v_add_f32 v33, 1.0, v33
    v_add_f32 v34, 1.0, v34
    v_mfma_f32_16x16x32_bf16 v[144:147], a[120:123], a[224:227], v[144:147]
    v_add_f32 v35, 1.0, v35
    v_rcp_f32 v32, v32
    v_mfma_f32_16x16x32_bf16 v[148:151], a[120:123], a[228:231], v[148:151]
    v_rcp_f32 v33, v33
    v_mfma_f32_16x16x32_bf16 v[152:155], a[120:123], a[232:235], v[152:155]
    buffer_load_dwordx4 v[204:207], v2, s[48:51], s11 offen offset:2048 sc1
    v_rcp_f32 v34, v34
    v_rcp_f32 v35, v35
    s_waitcnt vmcnt(27)
    v_mfma_f32_16x16x32_bf16 v[156:159], a[124:127], a[216:219], v[156:159]
    v_mul_f32 v84, v84, v32
    v_mul_f32 v85, v85, v33
    v_mul_f32 v86, v86, v34
    v_mfma_f32_16x16x32_bf16 v[160:163], a[124:127], a[220:223], v[160:163]
    v_mul_f32 v87, v87, v35
    ds_read_b128 v[44:47], v11 offset:3072
    v_mfma_f32_16x16x32_bf16 v[164:167], a[124:127], a[224:227], v[164:167]
    ds_read_b128 v[48:51], v11 offset:8192
    ds_read_b128 v[52:55], v11 offset:13312
    v_mfma_f32_16x16x32_bf16 v[168:171], a[124:127], a[228:231], v[168:171]
    v_mfma_f32_16x16x32_bf16 v[172:175], a[124:127], a[232:235], v[172:175]
    buffer_load_dwordx4 v[208:211], v2, s[48:51], s11 offen offset:3072 sc1
    s_waitcnt vmcnt(24)
    v_mfma_f32_16x16x32_bf16 v[96:99], a[128:131], a[236:239], v[96:99]
    v_mfma_f32_16x16x32_bf16 v[100:103], a[128:131], a[240:243], v[100:103]
    buffer_load_dwordx4 v[212:215], v12, s[48:51], s11 offen offset:0 sc1
    s_waitcnt lgkmcnt(2)
    v_add_f32 v88, v88, v44
    v_mfma_f32_16x16x32_bf16 v[104:107], a[128:131], a[244:247], v[104:107]
    s_add_u32 s8, s10, 36864
    buffer_load_dwordx4 a[96:99], v3, s[48:51], s8 offen sc1
    v_add_f32 v89, v89, v45
    v_add_f32 v90, v90, v46
    v_add_f32 v91, v91, v47
    v_mfma_f32_16x16x32_bf16 v[108:111], a[128:131], a[248:251], v[108:111]
    buffer_load_dwordx4 a[100:103], v4, s[48:51], s8 offen sc1
    s_waitcnt lgkmcnt(0)
    v_add_f32 v48, v48, v52
    v_add_f32 v49, v49, v53
    v_add_f32 v50, v50, v54
    v_mfma_f32_16x16x32_bf16 v[112:115], a[128:131], a[252:255], v[112:115]
    buffer_load_dwordx4 a[104:107], v5, s[48:51], s8 offen sc1
    v_add_f32 v51, v51, v55
    v_add_f32 v88, v88, v48
    v_add_f32 v89, v89, v49
    s_waitcnt vmcnt(27)
    v_mfma_f32_16x16x32_bf16 v[116:119], a[132:135], a[236:239], v[116:119]
    buffer_load_dwordx4 a[108:111], v6, s[48:51], s8 offen sc1
    v_add_f32 v90, v90, v50
    v_add_f32 v91, v91, v51
    v_mul_f32 v44, 0xbfb8aa3b, v88
    v_mfma_f32_16x16x32_bf16 v[120:123], a[132:135], a[240:243], v[120:123]
    v_mul_f32 v45, 0xbfb8aa3b, v89
    v_mul_f32 v46, 0xbfb8aa3b, v90
    v_mul_f32 v47, 0xbfb8aa3b, v91
    v_mfma_f32_16x16x32_bf16 v[124:127], a[132:135], a[244:247], v[124:127]
    v_exp_f32 v44, v44
    v_mfma_f32_16x16x32_bf16 v[128:131], a[132:135], a[248:251], v[128:131]
    v_exp_f32 v45, v45
    v_mfma_f32_16x16x32_bf16 v[132:135], a[132:135], a[252:255], v[132:135]
    v_exp_f32 v46, v46
    v_exp_f32 v47, v47
    s_waitcnt vmcnt(27)
    v_mfma_f32_16x16x32_bf16 v[136:139], a[136:139], a[236:239], v[136:139]
    v_add_f32 v44, 1.0, v44
    v_add_f32 v45, 1.0, v45
    v_add_f32 v46, 1.0, v46
    v_mfma_f32_16x16x32_bf16 v[140:143], a[136:139], a[240:243], v[140:143]
    v_add_f32 v47, 1.0, v47
    v_rcp_f32 v44, v44
    v_mfma_f32_16x16x32_bf16 v[144:147], a[136:139], a[244:247], v[144:147]
    v_rcp_f32 v45, v45
    v_mfma_f32_16x16x32_bf16 v[148:151], a[136:139], a[248:251], v[148:151]
    v_rcp_f32 v46, v46
    v_mfma_f32_16x16x32_bf16 v[152:155], a[136:139], a[252:255], v[152:155]
    v_rcp_f32 v47, v47
    v_mul_f32 v88, v88, v44
    v_mul_f32 v89, v89, v45
    s_waitcnt vmcnt(26)
    v_mfma_f32_16x16x32_bf16 v[156:159], a[140:143], a[236:239], v[156:159]
    v_mul_f32 v90, v90, v46
    v_mul_f32 v91, v91, v47
    v_mfma_f32_16x16x32_bf16 v[160:163], a[140:143], a[240:243], v[160:163]
    ds_read_b128 v[32:35], v11 offset:4096
    ds_read_b128 v[36:39], v11 offset:9216
    v_mfma_f32_16x16x32_bf16 v[164:167], a[140:143], a[244:247], v[164:167]
    ds_read_b128 v[40:43], v11 offset:14336
    v_mfma_f32_16x16x32_bf16 v[168:171], a[140:143], a[248:251], v[168:171]
    v_mfma_f32_16x16x32_bf16 v[172:175], a[140:143], a[252:255], v[172:175]
    s_waitcnt vmcnt(21)
    v_mfma_f32_16x16x32_bf16 v[96:99], a[144:147], a[160:163], v[96:99]
    s_waitcnt lgkmcnt(2)
    v_add_f32 v92, v92, v32
    v_add_f32 v93, v93, v33
    v_mfma_f32_16x16x32_bf16 v[100:103], a[144:147], a[164:167], v[100:103]
    v_add_f32 v94, v94, v34
    v_add_f32 v95, v95, v35
    v_mfma_f32_16x16x32_bf16 v[104:107], a[144:147], a[168:171], v[104:107]
    s_waitcnt lgkmcnt(0)
    v_add_f32 v36, v36, v40
    v_add_f32 v37, v37, v41
    v_add_f32 v38, v38, v42
    v_mfma_f32_16x16x32_bf16 v[108:111], a[144:147], a[172:175], v[108:111]
    v_add_f32 v39, v39, v43
    v_add_f32 v92, v92, v36
    v_add_f32 v93, v93, v37
    v_mfma_f32_16x16x32_bf16 v[112:115], a[144:147], a[176:179], v[112:115]
    v_add_f32 v94, v94, v38
    v_add_f32 v95, v95, v39
    s_waitcnt vmcnt(20)
    v_mfma_f32_16x16x32_bf16 v[116:119], a[148:151], a[160:163], v[116:119]
    v_mul_f32 v32, 0xbfb8aa3b, v92
    v_mul_f32 v33, 0xbfb8aa3b, v93
    v_mul_f32 v34, 0xbfb8aa3b, v94
    v_mfma_f32_16x16x32_bf16 v[120:123], a[148:151], a[164:167], v[120:123]
    v_mul_f32 v35, 0xbfb8aa3b, v95
    v_exp_f32 v32, v32
    v_mfma_f32_16x16x32_bf16 v[124:127], a[148:151], a[168:171], v[124:127]
    v_exp_f32 v33, v33
    v_mfma_f32_16x16x32_bf16 v[128:131], a[148:151], a[172:175], v[128:131]
    v_exp_f32 v34, v34
    v_exp_f32 v35, v35
    v_mfma_f32_16x16x32_bf16 v[132:135], a[148:151], a[176:179], v[132:135]
    v_add_f32 v32, 1.0, v32
    v_add_f32 v33, 1.0, v33
    v_add_f32 v34, 1.0, v34
    s_waitcnt vmcnt(19)
    v_mfma_f32_16x16x32_bf16 v[136:139], a[152:155], a[160:163], v[136:139]
    v_add_f32 v35, 1.0, v35
    v_rcp_f32 v32, v32
    v_mfma_f32_16x16x32_bf16 v[140:143], a[152:155], a[164:167], v[140:143]
    v_rcp_f32 v33, v33
    v_mfma_f32_16x16x32_bf16 v[144:147], a[152:155], a[168:171], v[144:147]
    v_rcp_f32 v34, v34
    v_mfma_f32_16x16x32_bf16 v[148:151], a[152:155], a[172:175], v[148:151]
    v_rcp_f32 v35, v35
    v_mul_f32 v92, v92, v32
    v_mul_f32 v93, v93, v33
    v_mfma_f32_16x16x32_bf16 v[152:155], a[152:155], a[176:179], v[152:155]
    v_mul_f32 v94, v94, v34
    v_mul_f32 v95, v95, v35
    v_add_u32 v7, -81920, v7
    s_waitcnt vmcnt(18)
    v_mfma_f32_16x16x32_bf16 v[156:159], a[156:159], a[160:163], v[156:159]
    v_add_u32 v8, -81920, v8
    v_add_u32 v9, -81920, v9
    v_mfma_f32_16x16x32_bf16 v[160:163], a[156:159], a[164:167], v[160:163]
    v_add_u32 v11, -81920, v11
    v_mfma_f32_16x16x32_bf16 v[164:167], a[156:159], a[168:171], v[164:167]
    v_mfma_f32_16x16x32_bf16 v[168:171], a[156:159], a[172:175], v[168:171]
    v_mfma_f32_16x16x32_bf16 v[172:175], a[156:159], a[176:179], v[172:175]
    s_waitcnt vmcnt(11)
    v_mfma_f32_16x16x32_bf16 v[116:119], a[84:87], v[176:179], v[116:119]
    v_mfma_f32_16x16x32_bf16 v[120:123], a[84:87], v[180:183], v[120:123]
    v_mfma_f32_16x16x32_bf16 v[124:127], a[84:87], v[184:187], v[124:127]
    v_mfma_f32_16x16x32_bf16 v[128:131], a[84:87], v[188:191], v[128:131]
    v_mfma_f32_16x16x32_bf16 v[132:135], a[84:87], v[192:195], v[132:135]
    s_waitcnt vmcnt(2)
    v_mfma_f32_16x16x32_bf16 v[116:119], a[100:103], v[196:199], v[116:119]
    v_mfma_f32_16x16x32_bf16 v[120:123], a[100:103], v[200:203], v[120:123]
    v_mfma_f32_16x16x32_bf16 v[124:127], a[100:103], v[204:207], v[124:127]
    v_mfma_f32_16x16x32_bf16 v[128:131], a[100:103], v[208:211], v[128:131]
    v_mfma_f32_16x16x32_bf16 v[132:135], a[100:103], v[212:215], v[132:135]
    v_mfma_f32_16x16x32_bf16 v[136:139], a[88:91], v[176:179], v[136:139]
    v_mfma_f32_16x16x32_bf16 v[140:143], a[88:91], v[180:183], v[140:143]
    v_mfma_f32_16x16x32_bf16 v[144:147], a[88:91], v[184:187], v[144:147]
    s_nop 0
    ds_write_b128 v7, v[116:119] offset:0
    v_mfma_f32_16x16x32_bf16 v[148:151], a[88:91], v[188:191], v[148:151]
    v_mfma_f32_16x16x32_bf16 v[152:155], a[88:91], v[192:195], v[152:155]
    ds_write_b128 v7, v[120:123] offset:1024
    s_waitcnt vmcnt(1)
    v_mfma_f32_16x16x32_bf16 v[136:139], a[104:107], v[196:199], v[136:139]
    v_mfma_f32_16x16x32_bf16 v[140:143], a[104:107], v[200:203], v[140:143]
    ds_write_b128 v7, v[124:127] offset:2048
    v_mfma_f32_16x16x32_bf16 v[144:147], a[104:107], v[204:207], v[144:147]
    v_mfma_f32_16x16x32_bf16 v[148:151], a[104:107], v[208:211], v[148:151]
    ds_write_b128 v7, v[128:131] offset:3072
    v_mfma_f32_16x16x32_bf16 v[152:155], a[104:107], v[212:215], v[152:155]
    v_mfma_f32_16x16x32_bf16 v[156:159], a[92:95], v[176:179], v[156:159]
    ds_write_b128 v7, v[132:135] offset:4096
    v_mfma_f32_16x16x32_bf16 v[160:163], a[92:95], v[180:183], v[160:163]
    v_mfma_f32_16x16x32_bf16 v[164:167], a[92:95], v[184:187], v[164:167]
    ds_write_b128 v8, v[136:139] offset:0
    v_mfma_f32_16x16x32_bf16 v[168:171], a[92:95], v[188:191], v[168:171]
    v_mfma_f32_16x16x32_bf16 v[172:175], a[92:95], v[192:195], v[172:175]
    ds_write_b128 v8, v[140:143] offset:1024
    s_waitcnt vmcnt(0)
    v_mfma_f32_16x16x32_bf16 v[156:159], a[108:111], v[196:199], v[156:159]
    v_mfma_f32_16x16x32_bf16 v[160:163], a[108:111], v[200:203], v[160:163]
    ds_write_b128 v8, v[144:147] offset:2048
    v_mfma_f32_16x16x32_bf16 v[164:167], a[108:111], v[204:207], v[164:167]
    v_mfma_f32_16x16x32_bf16 v[168:171], a[108:111], v[208:211], v[168:171]
    ds_write_b128 v8, v[148:151] offset:3072
    v_mfma_f32_16x16x32_bf16 v[172:175], a[108:111], v[212:215], v[172:175]
    v_mfma_f32_16x16x32_bf16 v[96:99], a[80:83], v[176:179], v[96:99]
    ds_write_b128 v8, v[152:155] offset:4096
    v_mfma_f32_16x16x32_bf16 v[100:103], a[80:83], v[180:183], v[100:103]
    v_mfma_f32_16x16x32_bf16 v[104:107], a[80:83], v[184:187], v[104:107]
    ds_write_b128 v9, v[156:159] offset:0
    v_mfma_f32_16x16x32_bf16 v[108:111], a[80:83], v[188:191], v[108:111]
    v_mfma_f32_16x16x32_bf16 v[112:115], a[80:83], v[192:195], v[112:115]
    ds_write_b128 v9, v[160:163] offset:1024
    v_mfma_f32_16x16x32_bf16 v[96:99], a[96:99], v[196:199], v[96:99]
    v_mfma_f32_16x16x32_bf16 v[100:103], a[96:99], v[200:203], v[100:103]
    ds_write_b128 v9, v[164:167] offset:2048
    v_mfma_f32_16x16x32_bf16 v[104:107], a[96:99], v[204:207], v[104:107]
    v_mfma_f32_16x16x32_bf16 v[108:111], a[96:99], v[208:211], v[108:111]
    ds_write_b128 v9, v[168:171] offset:3072
    v_mfma_f32_16x16x32_bf16 v[112:115], a[96:99], v[212:215], v[112:115]
    ds_write_b128 v9, v[172:175] offset:4096
    s_nop 0
    v_pk_fma_f32 v[56:57], v[96:97], v[76:77], v[56:57]
    v_pk_fma_f32 v[58:59], v[98:99], v[78:79], v[58:59]
    v_pk_fma_f32 v[60:61], v[100:101], v[80:81], v[60:61]
    v_pk_fma_f32 v[62:63], v[102:103], v[82:83], v[62:63]
    v_pk_fma_f32 v[64:65], v[104:105], v[84:85], v[64:65]
    v_pk_fma_f32 v[66:67], v[106:107], v[86:87], v[66:67]
    v_pk_fma_f32 v[68:69], v[108:109], v[88:89], v[68:69]
    v_pk_fma_f32 v[70:71], v[110:111], v[90:91], v[70:71]
    v_pk_fma_f32 v[72:73], v[112:113], v[92:93], v[72:73]
    v_pk_fma_f32 v[74:75], v[114:115], v[94:95], v[74:75]
    s_waitcnt lgkmcnt(0)
    s_barrier
    ds_read_b128 v[176:179], v11 offset:0
    ds_read_b128 v[196:199], v11 offset:5120
    ds_read_b128 v[216:219], v11 offset:10240
    ds_read_b128 v[180:183], v11 offset:1024
    ds_read_b128 v[200:203], v11 offset:6144
    ds_read_b128 v[220:223], v11 offset:11264
    ds_read_b128 v[184:187], v11 offset:2048
    ds_read_b128 v[204:207], v11 offset:7168
    ds_read_b128 v[224:227], v11 offset:12288
    ds_read_b128 v[188:191], v11 offset:3072
    ds_read_b128 v[208:211], v11 offset:8192
    ds_read_b128 v[228:231], v11 offset:13312
    ds_read_b128 v[192:195], v11 offset:4096
    ds_read_b128 v[212:215], v11 offset:9216
    ds_read_b128 v[232:235], v11 offset:14336
    s_waitcnt lgkmcnt(13)
    v_pk_add_f32 v[176:177], v[176:177], v[196:197]
    v_pk_add_f32 v[178:179], v[178:179], v[198:199]
    s_waitcnt lgkmcnt(12)
    v_pk_add_f32 v[176:177], v[176:177], v[216:217]
    v_pk_add_f32 v[178:179], v[178:179], v[218:219]
    v_pk_fma_f32 v[56:57], v[176:177], v[76:77], v[56:57]
    v_pk_fma_f32 v[58:59], v[178:179], v[78:79], v[58:59]
    buffer_store_dword v56, v13, s[52:55], s76 offen offset:0 sc1
    buffer_store_dword v57, v13, s[52:55], s77 offen offset:0 sc1
    buffer_store_dword v58, v13, s[52:55], s78 offen offset:0 sc1
    buffer_store_dword v59, v13, s[52:55], s79 offen offset:0 sc1
    s_waitcnt lgkmcnt(10)
    v_pk_add_f32 v[180:181], v[180:181], v[200:201]
    v_pk_add_f32 v[182:183], v[182:183], v[202:203]
    s_waitcnt lgkmcnt(9)
    v_pk_add_f32 v[180:181], v[180:181], v[220:221]
    v_pk_add_f32 v[182:183], v[182:183], v[222:223]
    v_pk_fma_f32 v[60:61], v[180:181], v[80:81], v[60:61]
    v_pk_fma_f32 v[62:63], v[182:183], v[82:83], v[62:63]
    buffer_store_dword v60, v13, s[52:55], s76 offen offset:64 sc1
    buffer_store_dword v61, v13, s[52:55], s77 offen offset:64 sc1
    buffer_store_dword v62, v13, s[52:55], s78 offen offset:64 sc1
    buffer_store_dword v63, v13, s[52:55], s79 offen offset:64 sc1
    s_waitcnt lgkmcnt(7)
    v_pk_add_f32 v[184:185], v[184:185], v[204:205]
    v_pk_add_f32 v[186:187], v[186:187], v[206:207]
    s_waitcnt lgkmcnt(6)
    v_pk_add_f32 v[184:185], v[184:185], v[224:225]
    v_pk_add_f32 v[186:187], v[186:187], v[226:227]
    v_pk_fma_f32 v[64:65], v[184:185], v[84:85], v[64:65]
    v_pk_fma_f32 v[66:67], v[186:187], v[86:87], v[66:67]
    buffer_store_dword v64, v13, s[52:55], s76 offen offset:128 sc1
    buffer_store_dword v65, v13, s[52:55], s77 offen offset:128 sc1
    buffer_store_dword v66, v13, s[52:55], s78 offen offset:128 sc1
    buffer_store_dword v67, v13, s[52:55], s79 offen offset:128 sc1
    s_waitcnt lgkmcnt(4)
    v_pk_add_f32 v[188:189], v[188:189], v[208:209]
    v_pk_add_f32 v[190:191], v[190:191], v[210:211]
    s_waitcnt lgkmcnt(3)
    v_pk_add_f32 v[188:189], v[188:189], v[228:229]
    v_pk_add_f32 v[190:191], v[190:191], v[230:231]
    v_pk_fma_f32 v[68:69], v[188:189], v[88:89], v[68:69]
    v_pk_fma_f32 v[70:71], v[190:191], v[90:91], v[70:71]
    buffer_store_dword v68, v13, s[52:55], s76 offen offset:192 sc1
    buffer_store_dword v69, v13, s[52:55], s77 offen offset:192 sc1
    buffer_store_dword v70, v13, s[52:55], s78 offen offset:192 sc1
    buffer_store_dword v71, v13, s[52:55], s79 offen offset:192 sc1
    s_waitcnt lgkmcnt(1)
    v_pk_add_f32 v[192:193], v[192:193], v[212:213]
    v_pk_add_f32 v[194:195], v[194:195], v[214:215]
    s_waitcnt lgkmcnt(0)
    v_pk_add_f32 v[192:193], v[192:193], v[232:233]
    v_pk_add_f32 v[194:195], v[194:195], v[234:235]
    v_pk_fma_f32 v[72:73], v[192:193], v[92:93], v[72:73]
    v_pk_fma_f32 v[74:75], v[194:195], v[94:95], v[74:75]
    buffer_store_dword v72, v13, s[52:55], s76 offen offset:256 sc1
    buffer_store_dword v73, v13, s[52:55], s77 offen offset:256 sc1
    buffer_store_dword v74, v13, s[52:55], s78 offen offset:256 sc1
    buffer_store_dword v75, v13, s[52:55], s79 offen offset:256 sc1
    s_endpgm
L_exit:
    s_endpgm
L_codeend:
    .fill 64, 4, 0xbf800000
.section .rodata,"a"
.p2align 6
.amdhsa_kernel recurrent_scan__ssm_conv_s5__glu_gated_swiglu__prompt_kernel
  .amdhsa_next_free_vgpr 512
  .amdhsa_next_free_sgpr 102
  .amdhsa_accum_offset 256
  .amdhsa_group_segment_fixed_size 0
  .amdhsa_kernarg_size 128
  .amdhsa_user_sgpr_count 2
  .amdhsa_user_sgpr_kernarg_segment_ptr 1
  .amdhsa_system_sgpr_workgroup_id_x 1
  .amdhsa_float_denorm_mode_32 3
.end_amdhsa_kernel
```
